```python
import torch

def _softmax(x, axis=-1):
    return torch.softmax(x, dim=axis)

def _gelu(x):
    return torch.nn.functional.gelu(x, approximate='tanh')

def _silu(x):
    return torch.nn.functional.silu(x)

def _sigmoid(x):
    return torch.sigmoid(x)

def _layernorm(x, axis=-1, eps=1e-05):
    m = x.mean(dim=axis, keepdim=True)
    v = x.var(dim=axis, keepdim=True, unbiased=False)
    return (x - m) / torch.sqrt(v + eps)

def _scatter_add(tgt, idx, src, axis=0):
    return tgt.clone().index_add_(axis, idx, src)

def _segment_sum(src, seg, n):
    out = torch.zeros((n,) + src.shape[1:], dtype=src.dtype)
    return out.index_add_(0, seg, src)

def _pad(x, pw):
    flat = tuple((v for pair in reversed(pw) for v in pair))
    return torch.nn.functional.pad(x, flat)
kernel_name = 'adaLN_cond__ssm_conv_s4__mixer_channel_mlp__prompt'

def setup_inputs():

    _w = lambda a: (lambda t: t.to(torch.bfloat16) if t.is_floating_point() else t)(torch.as_tensor(a))

    def _A_setup():
        B, L, D, N = (1, 2048, 576, 128)
        A_re = -(lambda _x: torch.exp(torch.as_tensor(_x)))((lambda *s: torch.randn(*s, dtype=torch.bfloat16) * 3.2)(D, N))
        A_im = torch.pi * (lambda *s: torch.randn(*s, dtype=torch.bfloat16) * 0.05)(D, N)
        B_re = (lambda *s: torch.randn(*s, dtype=torch.bfloat16) * 0.1)(D, N)
        B_im = (lambda *s: torch.randn(*s, dtype=torch.bfloat16) * 0.1)(D, N)
        C_re = (lambda *s: torch.randn(*s, dtype=torch.bfloat16) * 0.1)(D, N)
        C_im = (lambda *s: torch.randn(*s, dtype=torch.bfloat16) * 0.1)(D, N)
        log_dt = (lambda *s: torch.randn(*s, dtype=torch.bfloat16) * 0.05)(D) * 0.5 - 4.0
        Dskip = (lambda *s: torch.randn(*s, dtype=torch.bfloat16) * 0.05)(D)
        return {'u': _w((lambda *s: torch.randn(*s, dtype=torch.bfloat16) * 0.05)(B, L, D)), 'A_re': _w(A_re), 'A_im': _w(A_im), 'B_re': _w(B_re), 'B_im': _w(B_im), 'C_re': _w(C_re), 'C_im': _w(C_im), 'log_dt': _w(log_dt), 'Dskip': _w(Dskip)}
    _A_in = _A_setup()

    def _B_setup():
        B, S, D, F = (1, 2048, 576, 4608)
        return {'x': _w((lambda *s: torch.randn(*s, dtype=torch.bfloat16) * 0.05)(B, S, D)), 'w1': _w((lambda *s: torch.randn(*s, dtype=torch.bfloat16) * 3.2)(D, F) * D ** (-0.5)), 'b1': _w((lambda *s: torch.randn(*s, dtype=torch.bfloat16) * 1.6)(F)), 'w2': _w((lambda *s: torch.randn(*s, dtype=torch.bfloat16) * 0.8)(F, D) * F ** (-0.5)), 'b2': _w((lambda *s: torch.randn(*s, dtype=torch.bfloat16) * 0.8)(D))}
    _B_in = _B_setup()
    return {'A_u': _A_in['u'], 'A_A_re': _A_in['A_re'], 'A_A_im': _A_in['A_im'], 'A_B_re': _A_in['B_re'], 'A_B_im': _A_in['B_im'], 'A_C_re': _A_in['C_re'], 'A_C_im': _A_in['C_im'], 'A_log_dt': _A_in['log_dt'], 'A_Dskip': _A_in['Dskip'], 'B_x': _B_in['x'], 'B_w1': _B_in['w1'], 'B_b1': _B_in['b1'], 'B_w2': _B_in['w2'], 'B_b2': _B_in['b2'], 'c': _w((lambda *s: torch.randn(*s, dtype=torch.bfloat16) * 0.2)(1, 576) * 8.0), 'w_mod': _w((lambda *s: torch.randn(*s, dtype=torch.bfloat16) * 0.2)(576, 6 * 576) * 576 ** (-0.5) * 8.0)}

def reference(A_u, A_A_re, A_A_im, A_B_re, A_B_im, A_C_re, A_C_im, A_log_dt, A_Dskip, B_x, B_w1, B_b1, B_w2, B_b2, c, w_mod):

    def _A_ref(u, A_re, A_im, B_re, B_im, C_re, C_im, log_dt, Dskip):
        Bsz, L, D = u.shape
        dt = torch.exp(log_dt)[:, None]
        A = A_re + 1j * A_im
        Bc = B_re + 1j * B_im
        Cc = C_re + 1j * C_im
        logdA = dt * A
        dB = dt * Bc
        l = (lambda x, dt: x.to(dt))(torch.arange(L), A_re.dtype)
        P = torch.exp(logdA[:, :, None] * l[None, None, :])
        K = torch.einsum('dn,dnl,dn->dl', Cc, P, dB).real
        L2 = 2 * L
        Kp = _pad(K, ((0, 0), (0, L)))
        up = (lambda x, *d: x.permute(*d))(u, 0, 2, 1)
        up = _pad(up, ((0, 0), (0, 0), (0, L)))
        Kf = (lambda x, axes=(-2, -1): torch.fft.rfft2(x.float(), dim=axes))(Kp[:, None, :], axes=(-2, -1))
        Uf = (lambda x, axes=(-2, -1): torch.fft.rfft2(x.float(), dim=axes))(up[:, :, None, :], axes=(-2, -1))
        Yf = Uf * Kf[None, :, :, :]
        y = (lambda x, s, axes=(-2, -1): torch.fft.irfft2(x, s=s, dim=axes).to(torch.bfloat16))(Yf, (1, L2), axes=(-2, -1))[:, :, 0, :L]
        y = (lambda x, *d: x.permute(*d))(y, 0, 2, 1) + u * Dskip[None, None, :]
        return y

    def _B_ref(x, w1, b1, w2, b2):
        y = _layernorm(x, axis=-1)
        h = _gelu(torch.einsum('bsd,df->bsf', y, w1) + b1)
        return torch.einsum('bsf,fd->bsd', h, w2) + b2
    x = A_u
    mod = (_silu(c) @ w_mod).reshape(c.shape[0], 6, 1, -1)
    sa, ca, ga, sb, cb, gb = (mod[:, 0].clone(), mod[:, 1].clone(), mod[:, 2].clone(), mod[:, 3].clone(), mod[:, 4].clone(), mod[:, 5].clone())
    h = _layernorm(x, axis=-1) * (1 + ca) + sa
    x = x + ga * _A_ref(h, A_A_re, A_A_im, A_B_re, A_B_im, A_C_re, A_C_im, A_log_dt, A_Dskip)
    h = _layernorm(x, axis=-1) * (1 + cb) + sb
    x = x + gb * _B_ref(h, B_w1, B_b1, B_w2, B_b2)
    return x
```

```asm
; @launch kernel=ab_kernel grid=(256,1,1) block=(512,1,1) lds=156416
; @launch kernel=km_kernel grid=(256,1,1) block=(512,1,1) lds=163840
.amdgcn_target "amdgcn-amd-amdhsa--gfx950"
.text
.globl ab_kernel
.p2align 8
.type ab_kernel,@function
ab_kernel:
    s_cmp_ge_u32 s2, 256
    s_cbranch_scc1 L_ab_end
    s_load_dwordx2 s[4:5], s[0:1], 144
    s_load_dwordx2 s[6:7], s[0:1], 136
    s_mov_b32 s3, 0x40000
    s_bfe_u32 s17, s2, 0x20003
    s_lshl_b32 s17, s17, 13
    v_lshl_add_u32 v22, v0, 4, s17
    s_getpc_b64 s[20:21]
L_ab_kernel_pc_1:
    s_sub_u32 s20, s20, L_ab_kernel_pc_1-ab_kernel
    s_subb_u32 s21, s21, 0
    v_min_u32 v22, L_ab_end-ab_kernel-12, v22
    global_load_dwordx4 v[6:9], v22, s[20:21]
    v_lshrrev_b32 v4, 6, v0
    v_and_b32 v1, 63, v0
    v_readfirstlane_b32 s16, v4
    v_lshlrev_b32 v2, 4, v1
    s_cmp_ge_u32 s2, 112
    s_cbranch_scc1 L_ab_conv
    s_load_dwordx2 s[24:25], s[0:1], 120
    s_load_dwordx2 s[26:27], s[0:1], 112
    s_load_dwordx2 s[28:29], s[0:1], 0
    s_load_dwordx2 s[30:31], s[0:1], 80
    s_load_dwordx2 s[32:33], s[0:1], 88
    s_lshr_b32 s52, s2, 1
    s_and_b32 s56, s2, 1
    s_lshl_b32 s53, s52, 7
    s_mul_i32 s17, s56, 1990656
    s_add_u32 s53, s53, s17
    v_mov_b32 v4, 155648
    v_mov_b32 v5, 0
    ds_write_b32 v4, v5
    s_waitcnt lgkmcnt(0)
    s_barrier
    s_mov_b32 s12, s6
    s_mov_b32 s13, s7
    s_mov_b32 s14, 0x100
    s_mov_b32 s15, 0x20000
    s_cmp_lt_u32 s16, 4
    s_cbranch_scc1 L_ab_gp
    s_cmp_lg_u32 s2, 0
    s_cbranch_scc1 L_ab_nn
    s_cmp_lg_u32 s16, 7
    s_cbranch_scc1 L_ab_nn
    s_memrealtime s[8:9]
    s_add_u32 s36, s4, 0x3e9c000
    s_addc_u32 s37, s5, 0
    s_mov_b32 s38, 0x1000
    s_mov_b32 s39, 0x20000
    s_waitcnt lgkmcnt(0)
    s_or_b32 s9, s9, 0x40000000
    v_mov_b32 v28, s8
    v_mov_b32 v29, s9
    s_mov_b64 exec, 1
    buffer_store_dwordx2 v[28:29], off, s[12:15], 0 sc1
    buffer_store_dwordx2 v[28:29], off, s[36:39], 0 sc1
    s_mov_b64 exec, -1
L_ab_nn:
    s_lshl_b32 s55, s2, 1
    s_add_u32 s55, s55, s16
    s_sub_u32 s55, s55, 4
    s_cmp_lt_u32 s16, 6
    s_cbranch_scc1 L_ab_su
    s_cmp_lg_u32 s16, 6
    s_cbranch_scc1 L_ab_misc
    s_sub_u32 s55, s2, 72
    s_cmp_ge_u32 s55, 32
    s_cbranch_scc1 L_ab_misc
    s_add_u32 s55, s55, 224
L_ab_su:
    s_mov_b32 s36, s28
    s_mov_b32 s37, s29
    s_mov_b32 s38, 0x240000
    s_mov_b32 s39, 0x20000
    s_add_u32 s40, s4, 0x3e9d000
    s_addc_u32 s41, s5, 0
    s_mov_b32 s42, 0x8000
    s_mov_b32 s43, 0x20000
    v_lshrrev_b32 v32, 3, v1
    v_and_b32 v33, 7, v0
    v_mul_u32_u24 v34, 1152, v32
    v_lshl_add_u32 v34, v33, 4, v34
    s_mul_i32 s54, s55, 9216
    s_lshl_b32 s55, s55, 7
    buffer_load_dwordx4 v[40:43], v34, s[36:39], s54 offen offset:0
    buffer_load_dwordx4 v[44:47], v34, s[36:39], s54 offen offset:128
    buffer_load_dwordx4 v[48:51], v34, s[36:39], s54 offen offset:256
    buffer_load_dwordx4 v[52:55], v34, s[36:39], s54 offen offset:384
    buffer_load_dwordx4 v[56:59], v34, s[36:39], s54 offen offset:512
    buffer_load_dwordx4 v[60:63], v34, s[36:39], s54 offen offset:640
    buffer_load_dwordx4 v[64:67], v34, s[36:39], s54 offen offset:768
    buffer_load_dwordx4 v[68:71], v34, s[36:39], s54 offen offset:896
    buffer_load_dwordx4 v[72:75], v34, s[36:39], s54 offen offset:1024
    buffer_load_dword v22, off, s[12:15], 0
    s_branch L_ab_stb
L_ab_gp:
    s_cmp_ge_u32 s52, 54
    s_cbranch_scc1 L_ab_b1
    v_lshrrev_b32 v26, 3, v0
    v_and_b32 v27, 7, v0
    s_mul_i32 s54, s56, 576
    v_mul_u32_u24 v28, 6912, v26
    v_lshl_add_u32 v28, v27, 4, v28
    v_lshlrev_b32 v29, 1, v26
    s_add_u32 s57, s53, 0
    s_add_u32 s58, s53, 221184
    s_add_u32 s59, s53, 442368
    s_add_u32 s60, s53, 663552
    s_add_u32 s61, s53, 884736
    s_add_u32 s62, s53, 1105920
    s_add_u32 s63, s53, 1327104
    s_add_u32 s64, s53, 1548288
    s_add_u32 s65, s53, 1769472
    s_mov_b32 s36, s24
    s_mov_b32 s37, s25
    s_mov_b32 s38, 0x3cc000
    s_mov_b32 s39, 0x20000
    s_mov_b32 s40, s26
    s_mov_b32 s41, s27
    s_mov_b32 s42, 0x480
    s_mov_b32 s43, 0x20000
    buffer_load_ushort v31, v29, s[40:43], s54 offen offset:0
    buffer_load_ushort v32, v29, s[40:43], s54 offen offset:64
    buffer_load_ushort v33, v29, s[40:43], s54 offen offset:128
    buffer_load_ushort v34, v29, s[40:43], s54 offen offset:192
    buffer_load_ushort v35, v29, s[40:43], s54 offen offset:256
    buffer_load_ushort v36, v29, s[40:43], s54 offen offset:320
    buffer_load_ushort v37, v29, s[40:43], s54 offen offset:384
    buffer_load_ushort v38, v29, s[40:43], s54 offen offset:448
    buffer_load_ushort v39, v29, s[40:43], s54 offen offset:512
    buffer_load_dwordx4 v[64:67], v28, s[36:39], s57 offen
    buffer_load_dwordx4 v[68:71], v28, s[36:39], s58 offen
    buffer_load_dwordx4 v[72:75], v28, s[36:39], s59 offen
    buffer_load_dwordx4 v[76:79], v28, s[36:39], s60 offen
    buffer_load_dwordx4 v[80:83], v28, s[36:39], s61 offen
    buffer_load_dwordx4 v[84:87], v28, s[36:39], s62 offen
    buffer_load_dwordx4 v[88:91], v28, s[36:39], s63 offen
    buffer_load_dwordx4 v[92:95], v28, s[36:39], s64 offen
    buffer_load_dwordx4 v[96:99], v28, s[36:39], s65 offen
    buffer_load_dword v22, off, s[12:15], 0
    s_branch L_ab_gb
L_ab_conv:
    s_load_dwordx2 s[24:25], s[0:1], 8
    s_load_dwordx2 s[26:27], s[0:1], 16
    s_load_dwordx2 s[28:29], s[0:1], 24
    s_load_dwordx2 s[30:31], s[0:1], 32
    s_load_dwordx2 s[32:33], s[0:1], 40
    s_load_dwordx2 s[34:35], s[0:1], 48
    s_load_dwordx2 s[36:37], s[0:1], 56
    s_load_dwordx2 s[38:39], s[0:1], 0
    s_load_dwordx2 s[40:41], s[0:1], 64
    s_and_b32 s65, s16, 3
    s_lshr_b32 s66, s16, 2
    s_mul_i32 s69, s16, 14416
    s_mul_i32 s70, s65, 1600
    s_add_u32 s70, s70, 150024
    s_add_u32 s71, s65, 4
    s_mul_i32 s71, s71, 14416
    v_lshlrev_b32 v23, 1, v1
    s_getreg_b32 s67, hwreg(HW_REG_XCC_ID)
    s_and_b32 s67, s67, 7
    s_waitcnt lgkmcnt(0)
    s_mov_b32 s12, s6
    s_mov_b32 s13, s7
    s_mov_b32 s14, 0x100
    s_mov_b32 s15, 0x20000
    s_sub_u32 s17, s2, 112
    s_and_b32 s64, s17, 7
    s_mul_i32 s64, s64, 18
    s_lshr_b32 s17, s17, 3
    s_add_u32 s64, s64, s17
    s_lshl_b32 s67, s64, 2
    s_add_u32 s67, s67, s65
    s_lshl_b32 s68, s67, 8
    s_lshl_b32 s17, s66, 7
    s_add_u32 s68, s68, s17
    s_lshl_b32 s18, s67, 1
    s_mov_b32 s44, s36
    s_mov_b32 s45, s37
    s_mov_b32 s46, 0x480
    s_mov_b32 s47, 0x20000
    buffer_load_ushort v31, off, s[44:47], s18
    s_mov_b32 s48, s24
    s_mov_b32 s49, s25
    s_mov_b32 s50, 0x24000
    s_mov_b32 s51, 0x20000
    buffer_load_ushort v25, v23, s[48:51], s68 offen
    s_mov_b32 s52, s26
    s_mov_b32 s53, s27
    s_mov_b32 s54, 0x24000
    s_mov_b32 s55, 0x20000
    buffer_load_ushort v26, v23, s[52:55], s68 offen
    s_mov_b32 s56, s28
    s_mov_b32 s57, s29
    s_mov_b32 s58, 0x24000
    s_mov_b32 s59, 0x20000
    buffer_load_ushort v27, v23, s[56:59], s68 offen
    s_mov_b32 s60, s30
    s_mov_b32 s61, s31
    s_mov_b32 s62, 0x24000
    s_mov_b32 s63, 0x20000
    buffer_load_ushort v28, v23, s[60:63], s68 offen
    s_mov_b32 s48, s32
    s_mov_b32 s49, s33
    s_mov_b32 s50, 0x24000
    s_mov_b32 s51, 0x20000
    buffer_load_ushort v29, v23, s[48:51], s68 offen
    s_mov_b32 s44, s34
    s_mov_b32 s45, s35
    s_mov_b32 s46, 0x24000
    s_mov_b32 s47, 0x20000
    buffer_load_ushort v30, v23, s[44:47], s68 offen
    s_mov_b32 s48, s40
    s_mov_b32 s49, s41
    s_mov_b32 s50, 0x480
    s_mov_b32 s51, 0x20000
    buffer_load_ushort v32, off, s[48:51], s18
    s_mov_b32 s52, s38
    s_mov_b32 s53, s39
    s_mov_b32 s54, 0x240000
    s_mov_b32 s55, 0x20000
    v_mul_u32_u24 v33, 2304, v1
    v_bfe_u32 v4, v1, 1, 4
    v_mul_u32_u24 v4, 1152, v4
    v_and_b32 v5, 1, v1
    v_lshl_add_u32 v4, v5, 7, v4
    s_mul_i32 s17, s64, 3641
    s_lshr_b32 s17, s17, 16
    s_mul_i32 s18, s17, 144
    s_and_b32 s18, s18, 0xffffff80
    s_mul_i32 s17, s17, 18
    s_sub_u32 s17, s64, s17
    s_lshl_b32 s17, s17, 3
    s_add_u32 s17, s17, s16
    s_mul_i32 s17, s17, 18432
    s_add_u32 s17, s17, s18
    s_mov_b64 exec, 0xffffffff
    buffer_load_dword v24, v4, s[52:55], s17 offen
    s_mov_b64 exec, -1
    s_mul_i32 s73, s16, 294912
    s_lshl_b32 s17, s64, 3
    s_add_u32 s73, s73, s17
    s_add_u32 s56, s4, 0x3e9d000
    s_addc_u32 s57, s5, 0
    s_mov_b32 s58, 0x8000
    s_mov_b32 s59, 0x20000
    s_add_u32 s60, s4, 0x3ea5000
    s_addc_u32 s61, s5, 0
    s_mov_b32 s62, 0x1b000
    s_mov_b32 s63, 0x20000
    s_lshl_b32 s72, s66, 6
    v_add_u32 v72, s72, v1
    s_mul_i32 s17, s65, 16640
    v_lshl_add_u32 v76, v72, 4, s17
    v_lshlrev_b32 v72, 3, v72
    s_sub_u32 s72, s70, 34048
    v_add_u32 v36, -15, v72
    v_add_u32 v37, -14, v72
    v_add_u32 v38, -13, v72
    v_add_u32 v39, -12, v72
    v_add_u32 v40, -11, v72
    v_add_u32 v41, -10, v72
    v_add_u32 v42, -9, v72
    v_add_u32 v43, -8, v72
    v_add_u32 v44, -7, v72
    v_add_u32 v45, -6, v72
    v_add_u32 v46, -5, v72
    v_cvt_f32_i32 v73, v36
    v_cvt_f32_i32 v74, v37
    v_cvt_pk_bf16_f32 v73, v73, v74
    v_lshrrev_b32 v74, 16, v73
    v_and_b32 v73, 0xffff, v73
    v_lshl_add_u32 v73, v73, 1, s72
    v_cmp_gt_i32 vcc, 128, v36
    v_max_i32 v75, -1, v36
    v_lshl_add_u32 v75, v75, 1, s70
    v_cndmask_b32 v36, v73, v75, vcc
    v_lshl_add_u32 v74, v74, 1, s72
    v_cmp_gt_i32 vcc, 128, v37
    v_max_i32 v75, -1, v37
    v_lshl_add_u32 v75, v75, 1, s70
    v_cndmask_b32 v37, v74, v75, vcc
    v_cvt_f32_i32 v73, v38
    v_cvt_f32_i32 v74, v39
    v_cvt_pk_bf16_f32 v73, v73, v74
    v_lshrrev_b32 v74, 16, v73
    v_and_b32 v73, 0xffff, v73
    v_lshl_add_u32 v73, v73, 1, s72
    v_cmp_gt_i32 vcc, 128, v38
    v_max_i32 v75, -1, v38
    v_lshl_add_u32 v75, v75, 1, s70
    v_cndmask_b32 v38, v73, v75, vcc
    v_lshl_add_u32 v74, v74, 1, s72
    v_cmp_gt_i32 vcc, 128, v39
    v_max_i32 v75, -1, v39
    v_lshl_add_u32 v75, v75, 1, s70
    v_cndmask_b32 v39, v74, v75, vcc
    v_cvt_f32_i32 v73, v40
    v_cvt_f32_i32 v74, v41
    v_cvt_pk_bf16_f32 v73, v73, v74
    v_lshrrev_b32 v74, 16, v73
    v_and_b32 v73, 0xffff, v73
    v_lshl_add_u32 v73, v73, 1, s72
    v_cmp_gt_i32 vcc, 128, v40
    v_max_i32 v75, -1, v40
    v_lshl_add_u32 v75, v75, 1, s70
    v_cndmask_b32 v40, v73, v75, vcc
    v_lshl_add_u32 v74, v74, 1, s72
    v_cmp_gt_i32 vcc, 128, v41
    v_max_i32 v75, -1, v41
    v_lshl_add_u32 v75, v75, 1, s70
    v_cndmask_b32 v41, v74, v75, vcc
    v_cvt_f32_i32 v73, v42
    v_cvt_f32_i32 v74, v43
    v_cvt_pk_bf16_f32 v73, v73, v74
    v_lshrrev_b32 v74, 16, v73
    v_and_b32 v73, 0xffff, v73
    v_lshl_add_u32 v73, v73, 1, s72
    v_cmp_gt_i32 vcc, 128, v42
    v_max_i32 v75, -1, v42
    v_lshl_add_u32 v75, v75, 1, s70
    v_cndmask_b32 v42, v73, v75, vcc
    v_lshl_add_u32 v74, v74, 1, s72
    v_cmp_gt_i32 vcc, 128, v43
    v_max_i32 v75, -1, v43
    v_lshl_add_u32 v75, v75, 1, s70
    v_cndmask_b32 v43, v74, v75, vcc
    v_cvt_f32_i32 v73, v44
    v_cvt_f32_i32 v74, v45
    v_cvt_pk_bf16_f32 v73, v73, v74
    v_lshrrev_b32 v74, 16, v73
    v_and_b32 v73, 0xffff, v73
    v_lshl_add_u32 v73, v73, 1, s72
    v_cmp_gt_i32 vcc, 128, v44
    v_max_i32 v75, -1, v44
    v_lshl_add_u32 v75, v75, 1, s70
    v_cndmask_b32 v44, v73, v75, vcc
    v_lshl_add_u32 v74, v74, 1, s72
    v_cmp_gt_i32 vcc, 128, v45
    v_max_i32 v75, -1, v45
    v_lshl_add_u32 v75, v75, 1, s70
    v_cndmask_b32 v45, v74, v75, vcc
    v_cvt_f32_i32 v73, v46
    v_cvt_f32_i32 v74, v46
    v_cvt_pk_bf16_f32 v73, v73, v74
    v_lshrrev_b32 v74, 16, v73
    v_and_b32 v73, 0xffff, v73
    v_lshl_add_u32 v73, v73, 1, s72
    v_cmp_gt_i32 vcc, 128, v46
    v_max_i32 v75, -1, v46
    v_lshl_add_u32 v75, v75, 1, s70
    v_cndmask_b32 v46, v73, v75, vcc
    v_lshrrev_b32 v47, 2, v72
    s_add_u32 s17, s70, 1020
    v_add_u32 v47, s17, v47
    v_and_b32 v75, 16, v72
    v_lshlrev_b32 v75, 6, v75
    v_and_b32 v72, 8, v72
    v_add_u32 v72, v72, v75
    v_subrev_u32 v72, 1024, v72
    v_lshlrev_b32 v48, 1, v72
    s_mul_i32 s17, s65, 16640
    s_add_u32 s17, s17, 2048
    v_add_u32 v48, s17, v48
    s_cmp_eq_u32 s66, 0
    s_cbranch_scc0 L_ab_kernel_a3_2
    v_add_u32 v58, 2033, v72
    v_min_i32 v58, 2047, v58
    v_add_u32 v59, 2034, v72
    v_min_i32 v59, 2047, v59
    v_add_u32 v60, 2035, v72
    v_min_i32 v60, 2047, v60
    v_add_u32 v61, 2036, v72
    v_min_i32 v61, 2047, v61
    v_add_u32 v62, 2037, v72
    v_min_i32 v62, 2047, v62
    v_add_u32 v63, 2038, v72
    v_min_i32 v63, 2047, v63
    v_add_u32 v64, 2039, v72
    v_min_i32 v64, 2047, v64
    v_add_u32 v65, 2040, v72
    v_min_i32 v65, 2047, v65
    v_add_u32 v66, 2041, v72
    v_min_i32 v66, 2047, v66
    v_add_u32 v67, 2042, v72
    v_min_i32 v67, 2047, v67
    v_add_u32 v68, 2043, v72
    v_min_i32 v68, 2047, v68
    v_cvt_f32_i32 v73, v58
    v_cvt_f32_i32 v74, v59
    v_cvt_pk_bf16_f32 v73, v73, v74
    v_lshrrev_b32 v74, 16, v73
    v_and_b32 v73, 0xffff, v73
    v_lshl_add_u32 v58, v73, 1, s72
    v_lshl_add_u32 v59, v74, 1, s72
    v_cvt_f32_i32 v73, v60
    v_cvt_f32_i32 v74, v61
    v_cvt_pk_bf16_f32 v73, v73, v74
    v_lshrrev_b32 v74, 16, v73
    v_and_b32 v73, 0xffff, v73
    v_lshl_add_u32 v60, v73, 1, s72
    v_lshl_add_u32 v61, v74, 1, s72
    v_cvt_f32_i32 v73, v62
    v_cvt_f32_i32 v74, v63
    v_cvt_pk_bf16_f32 v73, v73, v74
    v_lshrrev_b32 v74, 16, v73
    v_and_b32 v73, 0xffff, v73
    v_lshl_add_u32 v62, v73, 1, s72
    v_lshl_add_u32 v63, v74, 1, s72
    v_cvt_f32_i32 v73, v64
    v_cvt_f32_i32 v74, v65
    v_cvt_pk_bf16_f32 v73, v73, v74
    v_lshrrev_b32 v74, 16, v73
    v_and_b32 v73, 0xffff, v73
    v_lshl_add_u32 v64, v73, 1, s72
    v_lshl_add_u32 v65, v74, 1, s72
    v_cvt_f32_i32 v73, v66
    v_cvt_f32_i32 v74, v67
    v_cvt_pk_bf16_f32 v73, v73, v74
    v_lshrrev_b32 v74, 16, v73
    v_and_b32 v73, 0xffff, v73
    v_lshl_add_u32 v66, v73, 1, s72
    v_lshl_add_u32 v67, v74, 1, s72
    v_cvt_f32_i32 v73, v68
    v_cvt_f32_i32 v74, v68
    v_cvt_pk_bf16_f32 v73, v73, v74
    v_lshrrev_b32 v74, 16, v73
    v_and_b32 v73, 0xffff, v73
    v_lshl_add_u32 v68, v73, 1, s72
L_ab_kernel_a3_2:
    v_lshl_add_u32 v77, v1, 2, s69
    v_and_b32 v4, 31, v1
    v_mul_u32_u24 v78, 272, v4
    v_lshrrev_b32 v5, 5, v1
    v_lshl_add_u32 v78, v5, 4, v78
    v_add_u32 v78, s69, v78
    s_cmp_eq_u32 s66, 0
    s_cbranch_scc0 L_ab_t0
    s_mul_i32 s17, s64, 9
    s_add_u32 s18, s17, s16
    s_add_u32 s17, s17, 8
    v_mov_b32 v192, s17
    v_mov_b32 v194, s18
    v_cmp_gt_u32 vcc, 4, v1
    v_and_b32 v5, 3, v1
    s_nop 0
    v_cndmask_b32 v192, v192, v194, vcc
    v_mul_u32_u24 v204, 58255, v192
    v_lshrrev_b32 v204, 19, v204
    v_mul_u32_u24 v195, 9, v204
    v_sub_u32 v193, v192, v195
    v_lshl_add_u32 v193, v193, 2, v5
    v_mul_u32_u24 v205, 1821, v204
    v_lshrrev_b32 v205, 16, v205
    v_mul_u32_u24 v195, 36, v205
    v_sub_u32 v192, v204, v195
    v_mul_u32_u24 v194, 57, v192
    v_lshrrev_b32 v194, 9, v194
    v_mul_u32_u24 v195, 9, v194
    v_sub_u32 v192, v192, v195
    v_mul_u32_u24 v196, 57, v193
    v_lshrrev_b32 v196, 9, v196
    v_mul_u32_u24 v195, 9, v196
    v_sub_u32 v193, v193, v195
    v_cmp_eq_u32 s[20:21], 8, v192
    v_lshrrev_b32 v197, 1, v192
    v_lshl_add_u32 v197, v197, 2, v194
    v_lshrrev_b32 v198, 1, v194
    v_add_u32 v198, 16, v198
    v_cndmask_b32 v197, v197, v198, s[20:21]
    v_cndmask_b32 v192, v192, v194, s[20:21]
    v_and_b32 v192, 1, v192
    v_lshl_add_u32 v195, v205, 1, 2
    v_sub_u32 v198, v193, v195
    v_and_b32 v198, 7, v198
    v_cmp_eq_u32 s[20:21], 8, v193
    v_mul_u32_u24 v199, 7, v197
    v_subrev_u32 v200, 12, v197
    v_cndmask_b32 v193, v198, 6, s[20:21]
    v_add_u32 v199, v199, v193
    v_cndmask_b32 v193, v198, 2, s[20:21]
    v_cndmask_b32 v198, v198, 8, s[20:21]
    v_mul_u32_u24 v201, 3, v200
    v_add_u32 v201, v201, v193
    v_add_u32 v201, 84, v201
    v_lshrrev_b32 v202, 1, v198
    v_mul_u32_u24 v202, 12, v202
    v_lshl_add_u32 v202, v200, 1, v202
    v_and_b32 v203, 1, v198
    v_add_u32 v202, v202, v203
    v_add_u32 v202, 90, v202
    v_subrev_u32 v195, 2, v198
    v_cmp_gt_u32 s[20:21], 4, v195
    v_lshl_add_u32 v203, v197, 1, v203
    v_add_u32 v203, 126, v203
    v_cndmask_b32 v201, v201, v202, s[20:21]
    v_cmp_le_u32 s[20:21], 12, v197
    v_subrev_u32 v195, 6, v198
    s_nop 0
    v_cndmask_b32 v199, v199, v201, s[20:21]
    v_cmp_gt_u32 s[20:21], 2, v195
    v_lshl_add_u32 v196, v205, 2, v196
    s_nop 0
    v_cndmask_b32 v199, v199, v203, s[20:21]
    v_mul_u32_u24 v200, 171, v199
    v_lshrrev_b32 v200, 11, v200
    v_add_u32 v200, v200, v192
    v_mul_u32_u24 v200, 12, v200
    v_add_u32 v199, v199, v200
    v_mul_u32_u24 v196, 336, v196
    v_add_u32 v199, v199, v196
    v_lshlrev_b32 v208, 10, v199
L_ab_t0:
    s_waitcnt vmcnt(2)
    v_lshlrev_b32 v31, 16, v31
    v_mul_f32 v31, 0x3fb8aa3b, v31
    v_exp_f32 v31, v31
    v_lshlrev_b32 v25, 16, v25
    v_lshlrev_b32 v26, 16, v26
    v_lshlrev_b32 v27, 16, v27
    v_lshlrev_b32 v28, 16, v28
    v_lshlrev_b32 v29, 16, v29
    v_lshlrev_b32 v30, 16, v30
    v_cvt_pk_bf16_f32 v31, v31, v31
    v_and_b32 v31, 0xffff0000, v31
    v_mul_f32 v25, v31, v25
    v_mul_f32 v26, v31, v26
    v_mul_f32 v27, v31, v27
    v_mul_f32 v28, v31, v28
    v_mul_f32 v25, 0x3fb8aa3b, v25
    v_mul_f32 v26, 0.15915494, v26
    v_mul_f32 v212, v30, v28
    v_mul_f32 v213, v30, v27
    v_fma_f32 v217, v29, v28, v213
    v_fma_f32 v216, v29, v27, -v212
    v_mul_f32 v234, 0x3f800000, v25
    v_mul_f32 v225, 0x3f800000, v26
    v_mul_f32 v235, 0x41000000, v25
    v_mul_f32 v227, 0x41000000, v26
    v_mul_f32 v236, 0x43800000, v25
    v_mul_f32 v229, 0x43800000, v26
    v_exp_f32 v234, v234
    v_fract_f32 v225, v225
    v_exp_f32 v235, v235
    v_fract_f32 v227, v227
    v_exp_f32 v236, v236
    v_fract_f32 v229, v229
    v_cos_f32 v224, v225
    v_sin_f32 v225, v225
    v_cos_f32 v226, v227
    v_sin_f32 v227, v227
    v_cos_f32 v228, v229
    v_sin_f32 v229, v229
    v_mul_f32 v224, v234, v224
    v_mul_f32 v225, v234, v225
    v_mul_f32 v226, v235, v226
    v_mul_f32 v227, v235, v227
    v_mul_f32 v228, v236, v228
    v_mul_f32 v229, v236, v229
    v_pk_mul_f32 v[212:213], v[224:225], v[224:225] op_sel:[1,1] op_sel_hi:[1,0] neg_lo:[0,1]
    v_pk_fma_f32 v[230:231], v[224:225], v[224:225], v[212:213] op_sel:[0,0,0] op_sel_hi:[0,1,1]
    v_pk_mul_f32 v[212:213], v[230:231], v[230:231] op_sel:[1,1] op_sel_hi:[1,0] neg_lo:[0,1]
    v_pk_fma_f32 v[232:233], v[230:231], v[230:231], v[212:213] op_sel:[0,0,0] op_sel_hi:[0,1,1]
    buffer_load_dwordx2 v[6:7], v33, s[52:55], s73 offen offset:0
    v_mov_b32 v240, 0x3f80
    ds_write_b32 v77, v240 offset:5712
    v_pk_mul_f32 v[212:213], v[216:217], v[228:229] op_sel:[1,1] op_sel_hi:[1,0] neg_lo:[0,1]
    v_pk_fma_f32 v[220:221], v[216:217], v[228:229], v[212:213] op_sel:[0,0,0] op_sel_hi:[0,1,1]
    v_cvt_pk_bf16_f32 v237, v226, v227
    ds_write_b32 v77, v237 offset:5984
    v_cvt_pk_bf16_f32 v238, v216, -v217
    ds_write_b32 v77, v238 offset:0
    v_pk_mul_f32 v[214:215], v[226:227], v[226:227] op_sel:[1,1] op_sel_hi:[1,0] neg_lo:[0,1]
    v_pk_fma_f32 v[218:219], v[226:227], v[226:227], v[214:215] op_sel:[0,0,0] op_sel_hi:[0,1,1]
    v_cvt_pk_bf16_f32 v239, v218, v219
    ds_write_b32 v77, v239 offset:6256
    v_pk_mul_f32 v[212:213], v[216:217], v[224:225] op_sel:[1,1] op_sel_hi:[1,0] neg_lo:[0,1]
    v_pk_fma_f32 v[216:217], v[216:217], v[224:225], v[212:213] op_sel:[0,0,0] op_sel_hi:[0,1,1]
    v_cvt_pk_bf16_f32 v240, v216, -v217
    ds_write_b32 v77, v240 offset:272
    v_pk_mul_f32 v[214:215], v[218:219], v[226:227] op_sel:[1,1] op_sel_hi:[1,0] neg_lo:[0,1]
    v_pk_fma_f32 v[218:219], v[218:219], v[226:227], v[214:215] op_sel:[0,0,0] op_sel_hi:[0,1,1]
    v_cvt_pk_bf16_f32 v237, v218, v219
    ds_write_b32 v77, v237 offset:6528
    v_pk_mul_f32 v[212:213], v[216:217], v[224:225] op_sel:[1,1] op_sel_hi:[1,0] neg_lo:[0,1]
    v_pk_fma_f32 v[216:217], v[216:217], v[224:225], v[212:213] op_sel:[0,0,0] op_sel_hi:[0,1,1]
    v_cvt_pk_bf16_f32 v238, v216, -v217
    ds_write_b32 v77, v238 offset:544
    v_pk_mul_f32 v[214:215], v[218:219], v[226:227] op_sel:[1,1] op_sel_hi:[1,0] neg_lo:[0,1]
    v_pk_fma_f32 v[218:219], v[218:219], v[226:227], v[214:215] op_sel:[0,0,0] op_sel_hi:[0,1,1]
    v_cvt_pk_bf16_f32 v239, v218, v219
    ds_write_b32 v77, v239 offset:6800
    v_pk_mul_f32 v[212:213], v[216:217], v[224:225] op_sel:[1,1] op_sel_hi:[1,0] neg_lo:[0,1]
    v_pk_fma_f32 v[216:217], v[216:217], v[224:225], v[212:213] op_sel:[0,0,0] op_sel_hi:[0,1,1]
    v_cvt_pk_bf16_f32 v240, v216, -v217
    ds_write_b32 v77, v240 offset:816
    v_pk_mul_f32 v[214:215], v[218:219], v[226:227] op_sel:[1,1] op_sel_hi:[1,0] neg_lo:[0,1]
    v_pk_fma_f32 v[218:219], v[218:219], v[226:227], v[214:215] op_sel:[0,0,0] op_sel_hi:[0,1,1]
    v_cvt_pk_bf16_f32 v237, v218, v219
    ds_write_b32 v77, v237 offset:7072
    v_pk_mul_f32 v[212:213], v[216:217], v[224:225] op_sel:[1,1] op_sel_hi:[1,0] neg_lo:[0,1]
    v_pk_fma_f32 v[216:217], v[216:217], v[224:225], v[212:213] op_sel:[0,0,0] op_sel_hi:[0,1,1]
    v_cvt_pk_bf16_f32 v238, v216, -v217
    ds_write_b32 v77, v238 offset:1088
    buffer_load_dwordx2 v[8:9], v33, s[52:55], s73 offen offset:1152
    v_pk_mul_f32 v[214:215], v[218:219], v[226:227] op_sel:[1,1] op_sel_hi:[1,0] neg_lo:[0,1]
    v_pk_fma_f32 v[218:219], v[218:219], v[226:227], v[214:215] op_sel:[0,0,0] op_sel_hi:[0,1,1]
    v_cvt_pk_bf16_f32 v239, v218, v219
    ds_write_b32 v77, v239 offset:7344
    v_pk_mul_f32 v[212:213], v[216:217], v[224:225] op_sel:[1,1] op_sel_hi:[1,0] neg_lo:[0,1]
    v_pk_fma_f32 v[216:217], v[216:217], v[224:225], v[212:213] op_sel:[0,0,0] op_sel_hi:[0,1,1]
    v_cvt_pk_bf16_f32 v240, v216, -v217
    ds_write_b32 v77, v240 offset:1360
    v_pk_mul_f32 v[214:215], v[218:219], v[226:227] op_sel:[1,1] op_sel_hi:[1,0] neg_lo:[0,1]
    v_pk_fma_f32 v[218:219], v[218:219], v[226:227], v[214:215] op_sel:[0,0,0] op_sel_hi:[0,1,1]
    v_cvt_pk_bf16_f32 v237, v218, v219
    ds_write_b32 v77, v237 offset:7616
    v_pk_mul_f32 v[212:213], v[216:217], v[224:225] op_sel:[1,1] op_sel_hi:[1,0] neg_lo:[0,1]
    v_pk_fma_f32 v[216:217], v[216:217], v[224:225], v[212:213] op_sel:[0,0,0] op_sel_hi:[0,1,1]
    v_cvt_pk_bf16_f32 v238, v216, -v217
    ds_write_b32 v77, v238 offset:1632
    v_pk_mul_f32 v[214:215], v[218:219], v[226:227] op_sel:[1,1] op_sel_hi:[1,0] neg_lo:[0,1]
    v_pk_fma_f32 v[218:219], v[218:219], v[226:227], v[214:215] op_sel:[0,0,0] op_sel_hi:[0,1,1]
    v_cvt_pk_bf16_f32 v239, v218, v219
    ds_write_b32 v77, v239 offset:7888
    v_pk_mul_f32 v[212:213], v[216:217], v[224:225] op_sel:[1,1] op_sel_hi:[1,0] neg_lo:[0,1]
    v_pk_fma_f32 v[216:217], v[216:217], v[224:225], v[212:213] op_sel:[0,0,0] op_sel_hi:[0,1,1]
    v_cvt_pk_bf16_f32 v240, v216, -v217
    ds_write_b32 v77, v240 offset:1904
    v_pk_mul_f32 v[214:215], v[218:219], v[226:227] op_sel:[1,1] op_sel_hi:[1,0] neg_lo:[0,1]
    v_pk_fma_f32 v[218:219], v[218:219], v[226:227], v[214:215] op_sel:[0,0,0] op_sel_hi:[0,1,1]
    v_cvt_pk_bf16_f32 v237, v218, v219
    ds_write_b32 v77, v237 offset:8160
    v_cvt_pk_bf16_f32 v238, v220, -v221
    ds_write_b32 v77, v238 offset:2176
    v_pk_mul_f32 v[214:215], v[218:219], v[226:227] op_sel:[1,1] op_sel_hi:[1,0] neg_lo:[0,1]
    v_pk_fma_f32 v[218:219], v[218:219], v[226:227], v[214:215] op_sel:[0,0,0] op_sel_hi:[0,1,1]
    v_cvt_pk_bf16_f32 v239, v218, v219
    ds_write_b32 v77, v239 offset:8432
    v_pk_mul_f32 v[212:213], v[220:221], v[230:231] op_sel:[1,1] op_sel_hi:[1,0] neg_lo:[0,1]
    v_pk_fma_f32 v[222:223], v[220:221], v[230:231], v[212:213] op_sel:[0,0,0] op_sel_hi:[0,1,1]
    v_cvt_pk_bf16_f32 v240, v222, -v223
    ds_write_b32 v77, v240 offset:2448
    v_pk_mul_f32 v[214:215], v[218:219], v[226:227] op_sel:[1,1] op_sel_hi:[1,0] neg_lo:[0,1]
    v_pk_fma_f32 v[218:219], v[218:219], v[226:227], v[214:215] op_sel:[0,0,0] op_sel_hi:[0,1,1]
    v_cvt_pk_bf16_f32 v237, v218, v219
    ds_write_b32 v77, v237 offset:8704
    v_pk_mul_f32 v[212:213], v[222:223], v[230:231] op_sel:[1,1] op_sel_hi:[1,0] neg_lo:[0,1]
    v_pk_fma_f32 v[222:223], v[222:223], v[230:231], v[212:213] op_sel:[0,0,0] op_sel_hi:[0,1,1]
    v_cvt_pk_bf16_f32 v238, v222, -v223
    ds_write_b32 v77, v238 offset:2720
    s_add_u32 s73, s73, 147456
    buffer_load_dwordx2 v[10:11], v33, s[52:55], s73 offen offset:0
    v_pk_mul_f32 v[214:215], v[218:219], v[226:227] op_sel:[1,1] op_sel_hi:[1,0] neg_lo:[0,1]
    v_pk_fma_f32 v[218:219], v[218:219], v[226:227], v[214:215] op_sel:[0,0,0] op_sel_hi:[0,1,1]
    v_cvt_pk_bf16_f32 v239, v218, v219
    ds_write_b32 v77, v239 offset:8976
    v_pk_mul_f32 v[212:213], v[222:223], v[230:231] op_sel:[1,1] op_sel_hi:[1,0] neg_lo:[0,1]
    v_pk_fma_f32 v[222:223], v[222:223], v[230:231], v[212:213] op_sel:[0,0,0] op_sel_hi:[0,1,1]
    v_cvt_pk_bf16_f32 v240, v222, -v223
    ds_write_b32 v77, v240 offset:2992
    v_pk_mul_f32 v[214:215], v[218:219], v[226:227] op_sel:[1,1] op_sel_hi:[1,0] neg_lo:[0,1]
    v_pk_fma_f32 v[218:219], v[218:219], v[226:227], v[214:215] op_sel:[0,0,0] op_sel_hi:[0,1,1]
    v_cvt_pk_bf16_f32 v237, v218, v219
    ds_write_b32 v77, v237 offset:9248
    v_pk_mul_f32 v[212:213], v[220:221], v[228:229] op_sel:[1,1] op_sel_hi:[1,0] neg_lo:[0,1]
    v_pk_fma_f32 v[220:221], v[220:221], v[228:229], v[212:213] op_sel:[0,0,0] op_sel_hi:[0,1,1]
    v_cvt_pk_bf16_f32 v238, v220, -v221
    ds_write_b32 v77, v238 offset:3264
    v_pk_mul_f32 v[214:215], v[218:219], v[226:227] op_sel:[1,1] op_sel_hi:[1,0] neg_lo:[0,1]
    v_pk_fma_f32 v[218:219], v[218:219], v[226:227], v[214:215] op_sel:[0,0,0] op_sel_hi:[0,1,1]
    v_cvt_pk_bf16_f32 v239, v218, v219
    ds_write_b32 v77, v239 offset:9520
    v_pk_mul_f32 v[212:213], v[220:221], v[232:233] op_sel:[1,1] op_sel_hi:[1,0] neg_lo:[0,1]
    v_pk_fma_f32 v[222:223], v[220:221], v[232:233], v[212:213] op_sel:[0,0,0] op_sel_hi:[0,1,1]
    v_cvt_pk_bf16_f32 v240, v222, -v223
    ds_write_b32 v77, v240 offset:3536
    v_pk_mul_f32 v[214:215], v[218:219], v[226:227] op_sel:[1,1] op_sel_hi:[1,0] neg_lo:[0,1]
    v_pk_fma_f32 v[218:219], v[218:219], v[226:227], v[214:215] op_sel:[0,0,0] op_sel_hi:[0,1,1]
    v_cvt_pk_bf16_f32 v237, v218, v219
    ds_write_b32 v77, v237 offset:9792
    v_pk_mul_f32 v[212:213], v[220:221], v[228:229] op_sel:[1,1] op_sel_hi:[1,0] neg_lo:[0,1]
    v_pk_fma_f32 v[220:221], v[220:221], v[228:229], v[212:213] op_sel:[0,0,0] op_sel_hi:[0,1,1]
    v_cvt_pk_bf16_f32 v238, v220, -v221
    ds_write_b32 v77, v238 offset:3808
    v_pk_mul_f32 v[214:215], v[218:219], v[226:227] op_sel:[1,1] op_sel_hi:[1,0] neg_lo:[0,1]
    v_pk_fma_f32 v[218:219], v[218:219], v[226:227], v[214:215] op_sel:[0,0,0] op_sel_hi:[0,1,1]
    v_cvt_pk_bf16_f32 v239, v218, v219
    ds_write_b32 v77, v239 offset:10064
    v_pk_mul_f32 v[212:213], v[220:221], v[232:233] op_sel:[1,1] op_sel_hi:[1,0] neg_lo:[0,1]
    v_pk_fma_f32 v[222:223], v[220:221], v[232:233], v[212:213] op_sel:[0,0,0] op_sel_hi:[0,1,1]
    v_cvt_pk_bf16_f32 v240, v222, -v223
    ds_write_b32 v77, v240 offset:4080
    v_pk_mul_f32 v[214:215], v[218:219], v[226:227] op_sel:[1,1] op_sel_hi:[1,0] neg_lo:[0,1]
    v_pk_fma_f32 v[218:219], v[218:219], v[226:227], v[214:215] op_sel:[0,0,0] op_sel_hi:[0,1,1]
    v_cvt_pk_bf16_f32 v237, v218, v219
    ds_write_b32 v77, v237 offset:10336
    v_pk_mul_f32 v[212:213], v[220:221], v[228:229] op_sel:[1,1] op_sel_hi:[1,0] neg_lo:[0,1]
    v_pk_fma_f32 v[220:221], v[220:221], v[228:229], v[212:213] op_sel:[0,0,0] op_sel_hi:[0,1,1]
    v_cvt_pk_bf16_f32 v238, v220, -v221
    ds_write_b32 v77, v238 offset:4352
    buffer_load_dwordx2 v[12:13], v33, s[52:55], s73 offen offset:1152
    v_pk_mul_f32 v[214:215], v[218:219], v[226:227] op_sel:[1,1] op_sel_hi:[1,0] neg_lo:[0,1]
    v_pk_fma_f32 v[218:219], v[218:219], v[226:227], v[214:215] op_sel:[0,0,0] op_sel_hi:[0,1,1]
    v_cvt_pk_bf16_f32 v239, v218, v219
    ds_write_b32 v77, v239 offset:10608
    v_pk_mul_f32 v[212:213], v[220:221], v[228:229] op_sel:[1,1] op_sel_hi:[1,0] neg_lo:[0,1]
    v_pk_fma_f32 v[220:221], v[220:221], v[228:229], v[212:213] op_sel:[0,0,0] op_sel_hi:[0,1,1]
    v_cvt_pk_bf16_f32 v240, v220, -v221
    ds_write_b32 v77, v240 offset:4624
    v_pk_mul_f32 v[214:215], v[218:219], v[226:227] op_sel:[1,1] op_sel_hi:[1,0] neg_lo:[0,1]
    v_pk_fma_f32 v[218:219], v[218:219], v[226:227], v[214:215] op_sel:[0,0,0] op_sel_hi:[0,1,1]
    v_cvt_pk_bf16_f32 v237, v218, v219
    ds_write_b32 v77, v237 offset:10880
    v_pk_mul_f32 v[212:213], v[220:221], v[228:229] op_sel:[1,1] op_sel_hi:[1,0] neg_lo:[0,1]
    v_pk_fma_f32 v[220:221], v[220:221], v[228:229], v[212:213] op_sel:[0,0,0] op_sel_hi:[0,1,1]
    v_cvt_pk_bf16_f32 v238, v220, -v221
    ds_write_b32 v77, v238 offset:4896
    v_pk_mul_f32 v[214:215], v[218:219], v[226:227] op_sel:[1,1] op_sel_hi:[1,0] neg_lo:[0,1]
    v_pk_fma_f32 v[218:219], v[218:219], v[226:227], v[214:215] op_sel:[0,0,0] op_sel_hi:[0,1,1]
    v_cvt_pk_bf16_f32 v239, v218, v219
    ds_write_b32 v77, v239 offset:11152
    v_pk_mul_f32 v[212:213], v[220:221], v[228:229] op_sel:[1,1] op_sel_hi:[1,0] neg_lo:[0,1]
    v_pk_fma_f32 v[220:221], v[220:221], v[228:229], v[212:213] op_sel:[0,0,0] op_sel_hi:[0,1,1]
    v_cvt_pk_bf16_f32 v240, v220, -v221
    ds_write_b32 v77, v240 offset:5168
    v_pk_mul_f32 v[214:215], v[218:219], v[226:227] op_sel:[1,1] op_sel_hi:[1,0] neg_lo:[0,1]
    v_pk_fma_f32 v[218:219], v[218:219], v[226:227], v[214:215] op_sel:[0,0,0] op_sel_hi:[0,1,1]
    v_cvt_pk_bf16_f32 v237, v218, v219
    ds_write_b32 v77, v237 offset:11424
    v_pk_mul_f32 v[212:213], v[220:221], v[228:229] op_sel:[1,1] op_sel_hi:[1,0] neg_lo:[0,1]
    v_pk_fma_f32 v[220:221], v[220:221], v[228:229], v[212:213] op_sel:[0,0,0] op_sel_hi:[0,1,1]
    v_cvt_pk_bf16_f32 v238, v220, -v221
    ds_write_b32 v77, v238 offset:5440
    v_pk_mul_f32 v[214:215], v[218:219], v[226:227] op_sel:[1,1] op_sel_hi:[1,0] neg_lo:[0,1]
    v_pk_fma_f32 v[218:219], v[218:219], v[226:227], v[214:215] op_sel:[0,0,0] op_sel_hi:[0,1,1]
    v_cvt_pk_bf16_f32 v239, v218, v219
    ds_write_b32 v77, v239 offset:11696
    v_pk_mul_f32 v[214:215], v[218:219], v[226:227] op_sel:[1,1] op_sel_hi:[1,0] neg_lo:[0,1]
    v_pk_fma_f32 v[218:219], v[218:219], v[226:227], v[214:215] op_sel:[0,0,0] op_sel_hi:[0,1,1]
    v_cvt_pk_bf16_f32 v240, v218, v219
    ds_write_b32 v77, v240 offset:11968
    v_pk_mul_f32 v[214:215], v[218:219], v[226:227] op_sel:[1,1] op_sel_hi:[1,0] neg_lo:[0,1]
    v_pk_fma_f32 v[218:219], v[218:219], v[226:227], v[214:215] op_sel:[0,0,0] op_sel_hi:[0,1,1]
    v_cvt_pk_bf16_f32 v237, v218, v219
    ds_write_b32 v77, v237 offset:12240
    v_pk_mul_f32 v[214:215], v[218:219], v[226:227] op_sel:[1,1] op_sel_hi:[1,0] neg_lo:[0,1]
    v_pk_fma_f32 v[218:219], v[218:219], v[226:227], v[214:215] op_sel:[0,0,0] op_sel_hi:[0,1,1]
    v_cvt_pk_bf16_f32 v238, v218, v219
    ds_write_b32 v77, v238 offset:12512
    v_pk_mul_f32 v[214:215], v[218:219], v[226:227] op_sel:[1,1] op_sel_hi:[1,0] neg_lo:[0,1]
    v_pk_fma_f32 v[218:219], v[218:219], v[226:227], v[214:215] op_sel:[0,0,0] op_sel_hi:[0,1,1]
    v_cvt_pk_bf16_f32 v239, v218, v219
    ds_write_b32 v77, v239 offset:12784
    v_pk_mul_f32 v[214:215], v[218:219], v[226:227] op_sel:[1,1] op_sel_hi:[1,0] neg_lo:[0,1]
    v_pk_fma_f32 v[218:219], v[218:219], v[226:227], v[214:215] op_sel:[0,0,0] op_sel_hi:[0,1,1]
    v_cvt_pk_bf16_f32 v240, v218, v219
    ds_write_b32 v77, v240 offset:13056
    buffer_load_dwordx2 v[34:35], off, s[12:15], 0 sc1
    v_pk_mul_f32 v[214:215], v[218:219], v[226:227] op_sel:[1,1] op_sel_hi:[1,0] neg_lo:[0,1]
    v_pk_fma_f32 v[218:219], v[218:219], v[226:227], v[214:215] op_sel:[0,0,0] op_sel_hi:[0,1,1]
    v_cvt_pk_bf16_f32 v237, v218, v219
    ds_write_b32 v77, v237 offset:13328
    v_pk_mul_f32 v[214:215], v[218:219], v[226:227] op_sel:[1,1] op_sel_hi:[1,0] neg_lo:[0,1]
    v_pk_fma_f32 v[218:219], v[218:219], v[226:227], v[214:215] op_sel:[0,0,0] op_sel_hi:[0,1,1]
    v_cvt_pk_bf16_f32 v238, v218, v219
    ds_write_b32 v77, v238 offset:13600
    v_pk_mul_f32 v[214:215], v[218:219], v[226:227] op_sel:[1,1] op_sel_hi:[1,0] neg_lo:[0,1]
    v_pk_fma_f32 v[218:219], v[218:219], v[226:227], v[214:215] op_sel:[0,0,0] op_sel_hi:[0,1,1]
    v_cvt_pk_bf16_f32 v239, v218, v219
    ds_write_b32 v77, v239 offset:13872
    v_pk_mul_f32 v[214:215], v[218:219], v[226:227] op_sel:[1,1] op_sel_hi:[1,0] neg_lo:[0,1]
    v_pk_fma_f32 v[218:219], v[218:219], v[226:227], v[214:215] op_sel:[0,0,0] op_sel_hi:[0,1,1]
    v_cvt_pk_bf16_f32 v240, v218, v219
    ds_write_b32 v77, v240 offset:14144
    s_waitcnt lgkmcnt(0)
    ds_read_b128 v[80:83], v78 offset:0
    ds_read_b128 v[112:115], v78 offset:5712
    ds_read_b128 v[84:87], v78 offset:32
    ds_read_b128 v[116:119], v78 offset:5744
    ds_read_b128 v[88:91], v78 offset:64
    ds_read_b128 v[120:123], v78 offset:5776
    ds_read_b128 v[92:95], v78 offset:96
    ds_read_b128 v[124:127], v78 offset:5808
    ds_read_b128 v[96:99], v78 offset:128
    ds_read_b128 v[128:131], v78 offset:5840
    ds_read_b128 v[100:103], v78 offset:160
    ds_read_b128 v[132:135], v78 offset:5872
    ds_read_b128 v[104:107], v78 offset:192
    ds_read_b128 v[136:139], v78 offset:5904
    ds_read_b128 v[108:111], v78 offset:224
    ds_read_b128 v[140:143], v78 offset:5936
    s_waitcnt lgkmcnt(14)
    v_mfma_f32_32x32x16_bf16 v[144:159], v[80:83], v[112:115], 0
    s_waitcnt lgkmcnt(12)
    v_mfma_f32_32x32x16_bf16 v[144:159], v[84:87], v[116:119], v[144:159]
    s_waitcnt lgkmcnt(10)
    v_mfma_f32_32x32x16_bf16 v[144:159], v[88:91], v[120:123], v[144:159]
    s_waitcnt lgkmcnt(8)
    v_mfma_f32_32x32x16_bf16 v[144:159], v[92:95], v[124:127], v[144:159]
    s_waitcnt lgkmcnt(6)
    v_mfma_f32_32x32x16_bf16 v[144:159], v[96:99], v[128:131], v[144:159]
    s_waitcnt lgkmcnt(4)
    v_mfma_f32_32x32x16_bf16 v[144:159], v[100:103], v[132:135], v[144:159]
    s_waitcnt lgkmcnt(2)
    v_mfma_f32_32x32x16_bf16 v[144:159], v[104:107], v[136:139], v[144:159]
    s_waitcnt lgkmcnt(0)
    v_mfma_f32_32x32x16_bf16 v[144:159], v[108:111], v[140:143], v[144:159]
    v_lshlrev_b32 v241, 5, v1
    v_lshrrev_b32 v242, 2, v1
    v_mul_u32_u24 v242, 576, v242
    v_and_b32 v4, 3, v1
    v_add_u32 v242, v242, v4
    v_lshlrev_b32 v242, 4, v242
    s_lshl_b32 s68, s16, 12
    s_lshl_b32 s69, s64, 6
    s_add_u32 s38, s69, 55296
    v_mov_b32 v184, 0
    v_mov_b32 v185, 0
    v_mov_b32 v186, 0
    v_mov_b32 v187, 0
    s_mul_i32 s18, s65, 4576
    s_add_u32 s18, s18, 119424
    v_add_u32 v4, s18, v2
    s_mov_b64 exec, 0x3fffffff
    ds_write_b128 v4, v[184:187]
    s_mov_b64 exec, -1
    v_and_b32 v176, 31, v1
    v_lshrrev_b32 v177, 5, v1
    v_lshlrev_b32 v178, 4, v176
    v_lshl_add_u32 v178, v177, 3, v178
    v_add_u32 v178, s70, v178
    v_cmp_eq_u32 vcc, 0, v177
    v_lshlrev_b32 v4, 3, v176
    v_lshlrev_b32 v5, 2, v176
    v_add_u32 v179, 512, v4
    v_add_u32 v180, 768, v5
    v_cndmask_b32 v179, v180, v179, vcc
    v_add_u32 v4, 516, v4
    v_add_u32 v180, 896, v5
    v_cndmask_b32 v180, v180, v4, vcc
    v_add_u32 v179, s70, v179
    v_add_u32 v180, s70, v180
    v_lshlrev_b32 v181, 1, v176
    v_lshl_add_u32 v181, v177, 8, v181
    v_add_u32 v181, s70, v181
    v_add_u32 v182, s71, v2
    s_cmp_eq_u32 s66, 0
    s_cbranch_scc1 L_ab_h0
    ds_write_b128 v182, v[144:147] offset:0
    ds_write_b128 v182, v[148:151] offset:1024
    ds_write_b128 v182, v[152:155] offset:2048
    s_waitcnt lgkmcnt(0)
    s_barrier
    s_mul_i32 s17, s64, 9
    s_add_u32 s18, s17, s16
    s_add_u32 s17, s17, 8
    v_mov_b32 v192, s17
    v_mov_b32 v194, s18
    v_cmp_gt_u32 vcc, 4, v1
    v_and_b32 v5, 3, v1
    s_nop 0
    v_cndmask_b32 v192, v192, v194, vcc
    v_mul_u32_u24 v204, 58255, v192
    v_lshrrev_b32 v204, 19, v204
    v_mul_u32_u24 v195, 9, v204
    v_sub_u32 v193, v192, v195
    v_lshl_add_u32 v193, v193, 2, v5
    v_mul_u32_u24 v205, 1821, v204
    v_lshrrev_b32 v205, 16, v205
    v_mul_u32_u24 v195, 36, v205
    v_sub_u32 v192, v204, v195
    v_mul_u32_u24 v194, 57, v192
    v_lshrrev_b32 v194, 9, v194
    v_mul_u32_u24 v195, 9, v194
    v_sub_u32 v192, v192, v195
    v_mul_u32_u24 v196, 57, v193
    v_lshrrev_b32 v196, 9, v196
    v_mul_u32_u24 v195, 9, v196
    v_sub_u32 v193, v193, v195
    v_cmp_eq_u32 s[20:21], 8, v192
    v_lshrrev_b32 v197, 1, v192
    v_lshl_add_u32 v197, v197, 2, v194
    v_lshrrev_b32 v198, 1, v194
    v_add_u32 v198, 16, v198
    v_cndmask_b32 v197, v197, v198, s[20:21]
    v_cndmask_b32 v192, v192, v194, s[20:21]
    v_and_b32 v192, 1, v192
    v_lshl_add_u32 v195, v205, 1, 2
    v_sub_u32 v198, v193, v195
    v_and_b32 v198, 7, v198
    v_cmp_eq_u32 s[20:21], 8, v193
    v_mul_u32_u24 v199, 7, v197
    v_subrev_u32 v200, 12, v197
    v_cndmask_b32 v193, v198, 6, s[20:21]
    v_add_u32 v199, v199, v193
    v_cndmask_b32 v193, v198, 2, s[20:21]
    v_cndmask_b32 v198, v198, 8, s[20:21]
    v_mul_u32_u24 v201, 3, v200
    v_add_u32 v201, v201, v193
    v_add_u32 v201, 84, v201
    v_lshrrev_b32 v202, 1, v198
    v_mul_u32_u24 v202, 12, v202
    v_lshl_add_u32 v202, v200, 1, v202
    v_and_b32 v203, 1, v198
    v_add_u32 v202, v202, v203
    v_add_u32 v202, 90, v202
    v_subrev_u32 v195, 2, v198
    v_cmp_gt_u32 s[20:21], 4, v195
    v_lshl_add_u32 v203, v197, 1, v203
    v_add_u32 v203, 126, v203
    v_cndmask_b32 v201, v201, v202, s[20:21]
    v_cmp_le_u32 s[20:21], 12, v197
    v_subrev_u32 v195, 6, v198
    s_nop 0
    v_cndmask_b32 v199, v199, v201, s[20:21]
    v_cmp_gt_u32 s[20:21], 2, v195
    v_lshl_add_u32 v196, v205, 2, v196
    s_nop 0
    v_cndmask_b32 v199, v199, v203, s[20:21]
    v_mul_u32_u24 v200, 171, v199
    v_lshrrev_b32 v200, 11, v200
    v_add_u32 v200, v200, v192
    v_mul_u32_u24 v200, 12, v200
    v_add_u32 v199, v199, v200
    v_mul_u32_u24 v196, 336, v196
    v_add_u32 v199, v199, v196
    v_lshlrev_b32 v208, 10, v199
    s_branch L_ab_join
L_ab_h0:
    s_waitcnt lgkmcnt(0)
    s_barrier
    ds_read_b128 v[80:83], v182 offset:0
    ds_read_b128 v[84:87], v182 offset:1024
    ds_read_b128 v[88:91], v182 offset:2048
    s_sub_u32 s18, s70, 4
    v_mov_b32 v5, s18
    s_waitcnt lgkmcnt(0)
    v_add_f32 v144, v144, v80
    v_add_f32 v145, v145, v81
    v_add_f32 v146, v146, v82
    v_add_f32 v147, v147, v83
    v_add_f32 v148, v148, v84
    v_add_f32 v149, v149, v85
    v_add_f32 v150, v150, v86
    v_add_f32 v151, v151, v87
    v_add_f32 v152, v152, v88
    v_add_f32 v153, v153, v89
    v_add_f32 v154, v154, v90
    v_add_f32 v155, v155, v91
    v_cvt_pk_bf16_f32 v112, v144, v145
    v_cvt_pk_bf16_f32 v113, v146, v147
    v_cvt_pk_bf16_f32 v114, v148, v149
    v_cvt_pk_bf16_f32 v115, v150, v151
    v_cvt_pk_bf16_f32 v116, v152, v153
    v_cvt_pk_bf16_f32 v117, v154, v155
    ds_write_b32 v5, v184
    ds_write_b64 v178, v[112:113]
    ds_write_b32 v179, v114
    ds_write_b32 v180, v115
    ds_write_b16 v181, v116 offset:1024
    ds_write_b16_d16_hi v181, v116 offset:1088
    ds_write_b16 v181, v117 offset:1152
    ds_write_b16_d16_hi v181, v117 offset:1216
    s_waitcnt lgkmcnt(0)
L_ab_join:
    s_barrier
    s_load_dwordx2 s[36:37], s[0:1], 96
    ds_read_u16 v80, v36
    ds_read_u16 v81, v37
    ds_read_u16 v82, v38
    ds_read_u16 v83, v39
    ds_read_u16 v84, v40
    ds_read_u16 v85, v41
    ds_read_u16 v86, v42
    ds_read_u16 v87, v43
    ds_read_u16 v88, v44
    ds_read_u16 v89, v45
    ds_read_u16 v90, v46
    ds_read_u16 v92, v47
    ds_read_u16 v93, v47 offset:2
    s_waitcnt lgkmcnt(2)
    v_lshl_or_b32 v120, v81, 16, v80
    v_lshl_or_b32 v121, v83, 16, v82
    v_lshl_or_b32 v122, v85, 16, v84
    v_lshl_or_b32 v123, v87, 16, v86
    ds_write_b128 v76, v[120:123] offset:0
    v_lshl_or_b32 v124, v82, 16, v81
    v_lshl_or_b32 v125, v84, 16, v83
    v_lshl_or_b32 v126, v86, 16, v85
    v_lshl_or_b32 v127, v88, 16, v87
    ds_write_b128 v76, v[124:127] offset:4160
    v_lshl_or_b32 v128, v83, 16, v82
    v_lshl_or_b32 v129, v85, 16, v84
    v_lshl_or_b32 v130, v87, 16, v86
    v_lshl_or_b32 v131, v89, 16, v88
    ds_write_b128 v76, v[128:131] offset:8320
    v_lshl_or_b32 v132, v84, 16, v83
    v_lshl_or_b32 v133, v86, 16, v85
    v_lshl_or_b32 v134, v88, 16, v87
    v_lshl_or_b32 v135, v90, 16, v89
    ds_write_b128 v76, v[132:135] offset:12480
    buffer_load_dwordx4 v[160:163], v241, s[56:59], s68 offen offset:0 sc1
    buffer_load_dwordx4 v[164:167], v241, s[56:59], s68 offen offset:16 sc1
    buffer_load_dwordx4 v[168:171], v241, s[56:59], s68 offen offset:2048 sc1
    buffer_load_dwordx4 v[172:175], v241, s[56:59], s68 offen offset:2064 sc1
    buffer_load_dwordx4 v[228:231], v242, s[60:63], s69 offen sc1
    buffer_load_dwordx4 v[232:235], v242, s[60:63], s38 offen sc1
    s_mov_b32 vcc_lo, 0xaaaaaaaa
    s_mov_b32 vcc_hi, 0xaaaaaaaa
    s_waitcnt lgkmcnt(4)
    v_cndmask_b32 v94, v92, v93, vcc
    v_lshl_or_b32 v136, v92, 16, v92
    v_lshl_or_b32 v138, v93, 16, v93
    v_lshl_or_b32 v137, v94, 16, v92
    v_lshl_or_b32 v141, v93, 16, v94
    v_mov_b32 v139, v138
    ds_write_b128 v76, v[136:139] offset:2048
    v_mov_b32 v140, v136
    v_mov_b32 v142, v138
    v_mov_b32 v143, v138
    ds_write_b128 v76, v[140:143] offset:6208
    v_mov_b32 v144, v137
    v_mov_b32 v145, v138
    v_mov_b32 v146, v138
    v_mov_b32 v147, v138
    ds_write_b128 v76, v[144:147] offset:10368
    v_mov_b32 v148, v141
    v_mov_b32 v149, v138
    v_mov_b32 v150, v138
    v_mov_b32 v151, v138
    ds_write_b128 v76, v[148:151] offset:14528
    s_cmp_eq_u32 s66, 0
    s_cbranch_scc0 L_ab_kernel_e3_3
    s_mov_b64 exec, 15
    v_mov_b32 v76, v48
    ds_read_u16 v104, v58
    ds_read_u16 v105, v59
    ds_read_u16 v106, v60
    ds_read_u16 v107, v61
    ds_read_u16 v108, v62
    ds_read_u16 v109, v63
    ds_read_u16 v110, v64
    ds_read_u16 v111, v65
    ds_read_u16 v112, v66
    ds_read_u16 v113, v67
    ds_read_u16 v114, v68
    s_waitcnt lgkmcnt(0)
    v_lshl_or_b32 v120, v105, 16, v104
    v_lshl_or_b32 v121, v107, 16, v106
    v_lshl_or_b32 v122, v109, 16, v108
    v_lshl_or_b32 v123, v111, 16, v110
    ds_write_b128 v76, v[120:123] offset:2048
    v_lshl_or_b32 v124, v106, 16, v105
    v_lshl_or_b32 v125, v108, 16, v107
    v_lshl_or_b32 v126, v110, 16, v109
    v_lshl_or_b32 v127, v112, 16, v111
    ds_write_b128 v76, v[124:127] offset:6208
    v_lshl_or_b32 v128, v107, 16, v106
    v_lshl_or_b32 v129, v109, 16, v108
    v_lshl_or_b32 v130, v111, 16, v110
    v_lshl_or_b32 v131, v113, 16, v112
    ds_write_b128 v76, v[128:131] offset:10368
    v_lshl_or_b32 v132, v108, 16, v107
    v_lshl_or_b32 v133, v110, 16, v109
    v_lshl_or_b32 v134, v112, 16, v111
    v_lshl_or_b32 v135, v114, 16, v113
    ds_write_b128 v76, v[132:135] offset:14528
    s_mov_b64 exec, -1
L_ab_kernel_e3_3:
    s_waitcnt vmcnt(6)
    v_readfirstlane_b32 s8, v34
    v_readfirstlane_b32 s9, v35
    s_nop 0
    s_cmp_lg_u64 s[8:9], 0
    s_cbranch_scc1 L_ab_kernel_tg_4
L_ab_kernel_gt_5:
    buffer_load_dwordx2 v[34:35], off, s[12:15], 0 sc1
    s_waitcnt vmcnt(0)
    v_readfirstlane_b32 s8, v34
    v_readfirstlane_b32 s9, v35
    s_nop 0
    s_cmp_lg_u64 s[8:9], 0
    s_cbranch_scc1 L_ab_kernel_gt_5x
    s_sleep 8
    s_sub_u32 s3, s3, 1
    s_cbranch_scc0 L_ab_kernel_gt_5
L_ab_kernel_gt_5x:
L_ab_kernel_tg_4:
    s_lshl_b32 s17, s16, 9
    s_add_u32 s18, s17, 133632
    v_lshl_add_u32 v243, v1, 2, s18
    s_sub_u32 s18, 119164, s17
    v_lshlrev_b32 v4, 2, v1
    v_sub_u32 v244, s18, v4
    s_mov_b32 s31, 0x05040100
    s_mov_b32 s32, 0x07060302
    v_perm_b32 v237, v8, v6, s31
    ds_write_b32 v243, v237 offset:0
    v_perm_b32 v238, v8, v6, s32
    ds_write_b32 v243, v238 offset:4096
    v_perm_b32 v239, v9, v7, s31
    ds_write_b32 v243, v239 offset:8192
    v_perm_b32 v240, v9, v7, s32
    ds_write_b32 v243, v240 offset:12288
    v_perm_b32 v237, v12, v10, s31
    ds_write_b32 v243, v237 offset:256
    v_perm_b32 v238, v12, v10, s32
    ds_write_b32 v243, v238 offset:4352
    v_perm_b32 v239, v13, v11, s31
    ds_write_b32 v243, v239 offset:8448
    v_perm_b32 v240, v13, v11, s32
    ds_write_b32 v243, v240 offset:12544
L_ab_kernel_rsp_7:
    s_waitcnt vmcnt(0)
    v_cmp_ne_u64 s[20:21], s[8:9], v[230:231]
    v_cmp_ne_u64 s[22:23], s[8:9], v[234:235]
    s_nop 0
    s_or_b64 s[20:21], s[20:21], s[22:23]
    s_and_b64 s[20:21], s[20:21], 0xffffff
    v_cmp_ne_u64 s[22:23], s[8:9], v[162:163]
    s_nop 0
    s_or_b64 s[20:21], s[20:21], s[22:23]
    v_cmp_ne_u64 s[22:23], s[8:9], v[166:167]
    s_nop 0
    s_or_b64 s[20:21], s[20:21], s[22:23]
    v_cmp_ne_u64 s[22:23], s[8:9], v[170:171]
    s_nop 0
    s_or_b64 s[20:21], s[20:21], s[22:23]
    v_cmp_ne_u64 s[22:23], s[8:9], v[174:175]
    s_nop 0
    s_or_b64 s[20:21], s[20:21], s[22:23]
    s_cmp_eq_u64 s[20:21], 0
    s_cbranch_scc1 L_ab_kernel_rok_6
    s_sleep 6
    buffer_load_dwordx4 v[160:163], v241, s[56:59], s68 offen offset:0 sc1
    buffer_load_dwordx4 v[164:167], v241, s[56:59], s68 offen offset:16 sc1
    buffer_load_dwordx4 v[168:171], v241, s[56:59], s68 offen offset:2048 sc1
    buffer_load_dwordx4 v[172:175], v241, s[56:59], s68 offen offset:2064 sc1
    buffer_load_dwordx4 v[228:231], v242, s[60:63], s69 offen sc1
    buffer_load_dwordx4 v[232:235], v242, s[60:63], s38 offen sc1
    s_sub_u32 s3, s3, 1
    s_cbranch_scc0 L_ab_kernel_rsp_7
    s_waitcnt vmcnt(0)
L_ab_kernel_rok_6:
    s_mov_b32 s60, s4
    s_mov_b32 s61, s5
    s_mov_b32 s62, 0x3600
    s_mov_b32 s63, 0x20000
    v_add_f32 v228, v228, v232
    v_cvt_pk_bf16_f32 v228, v228, v228
    v_and_b32 v228, 0xffff0000, v228
    v_add_f32 v245, 1.0, v228
    s_add_u32 s17, s65, 8
    s_add_u32 s18, s65, 16
    v_cvt_pk_bf16_f32 v245, v245, v245
    v_and_b32 v245, 0xffff0000, v245
    v_lshlrev_b32 v32, 16, v32
    v_readlane_b32 s28, v228, s17
    v_readlane_b32 s29, v245, s18
    v_readfirstlane_b32 s30, v32
    v_readlane_b32 s24, v245, 4
    v_readlane_b32 s17, v228, 0
    s_nop 1
    v_mov_b32 v246, s17
    v_readlane_b32 s25, v245, 5
    v_readlane_b32 s17, v228, 1
    s_nop 1
    v_mov_b32 v247, s17
    v_readlane_b32 s26, v245, 6
    v_readlane_b32 s17, v228, 2
    s_nop 1
    v_mov_b32 v248, s17
    v_readlane_b32 s27, v245, 7
    v_readlane_b32 s17, v228, 3
    s_nop 1
    v_mov_b32 v249, s17
    s_cmp_lg_u32 s16, 0
    s_cbranch_scc1 L_ab_nm
    v_lshrrev_b32 v242, 2, v242
    s_lshl_b32 s69, s64, 4
    s_mov_b64 exec, 0xf0ffff
    buffer_store_dword v228, v242, s[60:63], s69 offen sc1
    s_mov_b64 exec, 0x0f0000
    buffer_store_dword v245, v242, s[60:63], s69 offen sc1
    s_mov_b64 exec, -1
L_ab_nm:
    v_lshlrev_b32 v152, 16, v6
    v_and_b32 v153, 0xffff0000, v6
    v_lshlrev_b32 v154, 16, v7
    v_and_b32 v155, 0xffff0000, v7
    v_lshlrev_b32 v156, 16, v8
    v_and_b32 v157, 0xffff0000, v8
    v_lshlrev_b32 v158, 16, v9
    v_and_b32 v159, 0xffff0000, v9
    v_fma_f32 v152, v152, v160, v161
    v_fma_f32 v153, v153, v160, v161
    v_fma_f32 v154, v154, v160, v161
    v_fma_f32 v155, v155, v160, v161
    v_fma_f32 v156, v156, v164, v165
    v_fma_f32 v157, v157, v164, v165
    v_fma_f32 v158, v158, v164, v165
    v_fma_f32 v159, v159, v164, v165
    v_fma_f32 v152, v152, s24, v246
    v_fma_f32 v153, v153, s25, v247
    v_fma_f32 v154, v154, s26, v248
    v_fma_f32 v155, v155, s27, v249
    v_fma_f32 v156, v156, s24, v246
    v_fma_f32 v157, v157, s25, v247
    v_fma_f32 v158, v158, s26, v248
    v_fma_f32 v159, v159, s27, v249
    v_cvt_pk_bf16_f32 v237, v156, v152
    ds_write_b32 v244, v237 offset:256
    v_cvt_pk_bf16_f32 v238, v157, v153
    ds_write_b32 v244, v238 offset:4832
    v_cvt_pk_bf16_f32 v239, v158, v154
    ds_write_b32 v244, v239 offset:9408
    v_cvt_pk_bf16_f32 v240, v159, v155
    ds_write_b32 v244, v240 offset:13984
    v_lshlrev_b32 v152, 16, v10
    v_and_b32 v153, 0xffff0000, v10
    v_lshlrev_b32 v154, 16, v11
    v_and_b32 v155, 0xffff0000, v11
    v_lshlrev_b32 v156, 16, v12
    v_and_b32 v157, 0xffff0000, v12
    v_lshlrev_b32 v158, 16, v13
    v_and_b32 v159, 0xffff0000, v13
    v_fma_f32 v152, v152, v168, v169
    v_fma_f32 v153, v153, v168, v169
    v_fma_f32 v154, v154, v168, v169
    v_fma_f32 v155, v155, v168, v169
    v_fma_f32 v156, v156, v172, v173
    v_fma_f32 v157, v157, v172, v173
    v_fma_f32 v158, v158, v172, v173
    v_fma_f32 v159, v159, v172, v173
    v_fma_f32 v152, v152, s24, v246
    v_fma_f32 v153, v153, s25, v247
    v_fma_f32 v154, v154, s26, v248
    v_fma_f32 v155, v155, s27, v249
    v_fma_f32 v156, v156, s24, v246
    v_fma_f32 v157, v157, s25, v247
    v_fma_f32 v158, v158, s26, v248
    v_fma_f32 v159, v159, s27, v249
    v_cvt_pk_bf16_f32 v237, v156, v152
    ds_write_b32 v244, v237 offset:0
    v_cvt_pk_bf16_f32 v238, v157, v153
    ds_write_b32 v244, v238 offset:4576
    v_cvt_pk_bf16_f32 v239, v158, v154
    ds_write_b32 v244, v239 offset:9152
    v_cvt_pk_bf16_f32 v240, v159, v155
    ds_write_b32 v244, v240 offset:13728
    v_and_b32 v4, 15, v1
    v_lshrrev_b32 v5, 4, v1
    v_lshlrev_b32 v252, 5, v4
    v_and_b32 v250, 3, v1
    v_mul_u32_u24 v250, 4160, v250
    v_and_b32 v251, 12, v1
    v_lshl_add_u32 v250, v251, 1, v250
    v_lshl_add_u32 v250, v5, 4, v250
    s_mul_i32 s17, s65, 16640
    s_lshl_b32 s18, s66, 8
    s_add_u32 s17, s17, s18
    v_add_u32 v250, s17, v250
    v_lshlrev_b32 v251, 4, v5
    v_sub_u32 v251, v251, v252
    s_mul_i32 s17, s65, 4576
    s_add_u32 s17, s17, s18
    s_add_u32 s17, s17, 115808
    v_add_u32 v251, s17, v251
    v_lshl_add_u32 v252, v5, 3, v252
    s_waitcnt lgkmcnt(0)
    s_barrier
    ds_read_b128 v[112:115], v251 offset:3584
    ds_read_b64 v[80:81], v250 offset:0
    ds_read_b64 v[82:83], v250 offset:8
    ds_read_b128 v[116:119], v251 offset:3072
    ds_read_b64 v[84:85], v250 offset:512
    ds_read_b64 v[86:87], v250 offset:520
    ds_read_b128 v[120:123], v251 offset:2560
    ds_read_b64 v[88:89], v250 offset:1024
    ds_read_b64 v[90:91], v250 offset:1032
    ds_read_b128 v[124:127], v251 offset:2048
    ds_read_b64 v[92:93], v250 offset:1536
    ds_read_b64 v[94:95], v250 offset:1544
    ds_read_b128 v[128:131], v251 offset:1536
    ds_read_b64 v[96:97], v250 offset:2048
    ds_read_b64 v[98:99], v250 offset:2056
    ds_read_b128 v[132:135], v251 offset:1024
    ds_read_b64 v[100:101], v250 offset:2560
    ds_read_b64 v[102:103], v250 offset:2568
    ds_read_b128 v[136:139], v251 offset:512
    ds_read_b64 v[104:105], v250 offset:3072
    ds_read_b64 v[106:107], v250 offset:3080
    ds_read_b128 v[140:143], v251 offset:0
    ds_read_b64 v[108:109], v250 offset:3584
    ds_read_b64 v[110:111], v250 offset:3592
    s_waitcnt lgkmcnt(15)
    v_mfma_f32_16x16x32_bf16 v[36:39], v[80:83], v[112:115], 0
    ds_read_b128 v[176:179], v251 offset:3648
    s_mov_b32 s52, s36
    s_waitcnt lgkmcnt(15)
    v_mfma_f32_16x16x32_bf16 v[40:43], v[80:83], v[116:119], 0
    ds_read_b64 v[144:145], v250 offset:64
    s_mov_b32 s53, s37
    v_mfma_f32_16x16x32_bf16 v[40:43], v[84:87], v[112:115], v[40:43]
    ds_read_b64 v[146:147], v250 offset:72
    s_mov_b32 s54, 0x510000
    v_mfma_f32_16x16x32_bf16 v[44:47], v[84:87], v[116:119], 0
    ds_read_b128 v[180:183], v251 offset:3136
    s_mov_b32 s55, 0x20000
    s_waitcnt lgkmcnt(15)
    v_mfma_f32_16x16x32_bf16 v[44:47], v[80:83], v[120:123], v[44:47]
    ds_read_b64 v[148:149], v250 offset:576
    s_add_u32 s56, s4, 0x151c000
    v_mfma_f32_16x16x32_bf16 v[48:51], v[84:87], v[120:123], 0
    ds_read_b64 v[150:151], v250 offset:584
    s_addc_u32 s57, s5, 0
    v_mfma_f32_16x16x32_bf16 v[44:47], v[88:91], v[112:115], v[44:47]
    ds_read_b128 v[184:187], v251 offset:2624
    s_mov_b32 s58, 0x540000
    v_mfma_f32_16x16x32_bf16 v[48:51], v[88:91], v[116:119], v[48:51]
    ds_read_b64 v[152:153], v250 offset:1088
    s_mov_b32 s59, 0x20000
    v_mfma_f32_16x16x32_bf16 v[52:55], v[88:91], v[120:123], 0
    ds_read_b64 v[154:155], v250 offset:1096
    v_lshrrev_b32 v4, 3, v1
    s_waitcnt lgkmcnt(15)
    v_mfma_f32_16x16x32_bf16 v[48:51], v[80:83], v[124:127], v[48:51]
    ds_read_b128 v[188:191], v251 offset:2112
    v_mul_u32_u24 v241, 1152, v4
    v_mfma_f32_16x16x32_bf16 v[52:55], v[84:87], v[124:127], v[52:55]
    ds_read_b64 v[156:157], v250 offset:1600
    v_and_b32 v5, 7, v1
    v_mfma_f32_16x16x32_bf16 v[56:59], v[88:91], v[124:127], 0
    ds_read_b64 v[158:159], v250 offset:1608
    v_lshl_add_u32 v241, v5, 4, v241
    v_mfma_f32_16x16x32_bf16 v[48:51], v[92:95], v[112:115], v[48:51]
    ds_read_b128 v[192:195], v251 offset:1600
    s_mul_i32 s33, s64, 9
    v_mfma_f32_16x16x32_bf16 v[52:55], v[92:95], v[116:119], v[52:55]
    ds_read_b64 v[160:161], v250 offset:2112
    s_add_u32 s33, s33, s16
    v_mfma_f32_16x16x32_bf16 v[56:59], v[92:95], v[120:123], v[56:59]
    ds_read_b64 v[162:163], v250 offset:2120
    s_mul_i32 s35, s33, 58255
    v_mfma_f32_16x16x32_bf16 v[60:63], v[92:95], v[124:127], 0
    ds_read_b128 v[196:199], v251 offset:1088
    s_lshr_b32 s35, s35, 19
    s_waitcnt lgkmcnt(15)
    v_mfma_f32_16x16x32_bf16 v[52:55], v[80:83], v[128:131], v[52:55]
    ds_read_b64 v[164:165], v250 offset:2624
    s_mul_i32 s17, s35, 9
    v_mfma_f32_16x16x32_bf16 v[56:59], v[84:87], v[128:131], v[56:59]
    ds_read_b64 v[166:167], v250 offset:2632
    s_sub_u32 s38, s33, s17
    v_mfma_f32_16x16x32_bf16 v[60:63], v[88:91], v[128:131], v[60:63]
    ds_read_b128 v[200:203], v251 offset:576
    s_lshl_b32 s17, s38, 7
    v_mfma_f32_16x16x32_bf16 v[64:67], v[92:95], v[128:131], 0
    ds_read_b64 v[168:169], v250 offset:3136
    s_mul_i32 s18, s35, 36864
    v_mfma_f32_16x16x32_bf16 v[52:55], v[96:99], v[112:115], v[52:55]
    ds_read_b64 v[170:171], v250 offset:3144
    s_add_u32 s17, s17, s18
    v_mfma_f32_16x16x32_bf16 v[56:59], v[96:99], v[116:119], v[56:59]
    ds_read_b128 v[204:207], v251 offset:64
    s_lshl_b32 s18, s16, 12
    v_mfma_f32_16x16x32_bf16 v[60:63], v[96:99], v[120:123], v[60:63]
    ds_read_b64 v[172:173], v250 offset:3648
    s_add_u32 m0, s18, 66560
    v_mfma_f32_16x16x32_bf16 v[64:67], v[96:99], v[124:127], v[64:67]
    ds_read_b64 v[174:175], v250 offset:3656
    buffer_load_dwordx4 v241, s[52:55], s17 offen  lds
    s_waitcnt lgkmcnt(15)
    v_mfma_f32_16x16x32_bf16 v[56:59], v[80:83], v[132:135], v[56:59]
    s_add_u32 s17, s17, 9216
    v_mfma_f32_16x16x32_bf16 v[60:63], v[84:87], v[132:135], v[60:63]
    s_add_u32 m0, s18, 67584
    v_mfma_f32_16x16x32_bf16 v[64:67], v[88:91], v[132:135], v[64:67]
    buffer_load_dwordx4 v241, s[52:55], s17 offen  lds
    v_mfma_f32_16x16x32_bf16 v[56:59], v[100:103], v[112:115], v[56:59]
    s_add_u32 s17, s17, 9216
    v_mfma_f32_16x16x32_bf16 v[60:63], v[100:103], v[116:119], v[60:63]
    s_add_u32 m0, s18, 68608
    v_mfma_f32_16x16x32_bf16 v[64:67], v[100:103], v[120:123], v[64:67]
    buffer_load_dwordx4 v241, s[52:55], s17 offen  lds
    s_waitcnt lgkmcnt(15)
    v_mfma_f32_16x16x32_bf16 v[60:63], v[80:83], v[136:139], v[60:63]
    s_add_u32 s17, s17, 9216
    v_mfma_f32_16x16x32_bf16 v[64:67], v[84:87], v[136:139], v[64:67]
    s_add_u32 m0, s18, 69632
    v_mfma_f32_16x16x32_bf16 v[60:63], v[104:107], v[112:115], v[60:63]
    buffer_load_dwordx4 v241, s[52:55], s17 offen  lds
    v_mfma_f32_16x16x32_bf16 v[64:67], v[104:107], v[116:119], v[64:67]
    s_cmp_lg_u32 s16, 0
    s_cbranch_scc1 L_ab_u8a
    s_mul_i32 s33, s64, 9
    s_add_u32 s33, s33, 8
    s_mul_i32 s35, s33, 58255
    s_lshr_b32 s35, s35, 19
    s_mul_i32 s17, s35, 9
    s_sub_u32 s38, s33, s17
    s_lshl_b32 s17, s38, 7
    s_mul_i32 s18, s35, 36864
    s_add_u32 s17, s17, s18
    s_lshl_b32 s18, s16, 12
    s_add_u32 m0, s18, 99328
    s_nop 0
    buffer_load_dwordx4 v241, s[52:55], s17 offen  lds
    s_add_u32 s17, s17, 9216
    s_add_u32 m0, s18, 100352
    s_nop 0
    buffer_load_dwordx4 v241, s[52:55], s17 offen  lds
    s_add_u32 s17, s17, 9216
    s_add_u32 m0, s18, 101376
    s_nop 0
    buffer_load_dwordx4 v241, s[52:55], s17 offen  lds
    s_add_u32 s17, s17, 9216
    s_add_u32 m0, s18, 102400
    s_nop 0
    buffer_load_dwordx4 v241, s[52:55], s17 offen  lds
L_ab_u8a:
    s_waitcnt lgkmcnt(15)
    v_mfma_f32_16x16x32_bf16 v[64:67], v[80:83], v[140:143], v[64:67]
    v_lshrrev_b32 v242, 5, v1
    v_mfma_f32_16x16x32_bf16 v[64:67], v[108:111], v[112:115], v[64:67]
    v_lshlrev_b32 v242, 2, v242
    s_waitcnt lgkmcnt(0)
    v_mfma_f32_16x16x32_bf16 v[36:39], v[144:147], v[176:179], v[36:39]
    ds_read_b128 v[112:115], v251 offset:3712
    v_bfe_u32 v5, v1, 4, 1
    v_mfma_f32_16x16x32_bf16 v[40:43], v[144:147], v[180:183], v[40:43]
    ds_read_b64 v[80:81], v250 offset:128
    v_lshl_add_u32 v242, v5, 4, v242
    v_mfma_f32_16x16x32_bf16 v[40:43], v[148:151], v[176:179], v[40:43]
    ds_read_b64 v[82:83], v250 offset:136
    v_bfe_u32 v5, v1, 2, 2
    v_mfma_f32_16x16x32_bf16 v[44:47], v[148:151], v[180:183], v[44:47]
    ds_read_b128 v[116:119], v251 offset:3200
    v_add_u32 v242, v242, v5
    v_mfma_f32_16x16x32_bf16 v[44:47], v[144:147], v[184:187], v[44:47]
    ds_read_b64 v[84:85], v250 offset:640
    v_lshlrev_b32 v242, 7, v242
    v_mfma_f32_16x16x32_bf16 v[48:51], v[148:151], v[184:187], v[48:51]
    ds_read_b64 v[86:87], v250 offset:648
    v_and_b32 v5, 3, v1
    v_mfma_f32_16x16x32_bf16 v[44:47], v[152:155], v[176:179], v[44:47]
    ds_read_b128 v[120:123], v251 offset:2688
    v_lshl_add_u32 v242, v5, 3, v242
    v_mfma_f32_16x16x32_bf16 v[48:51], v[152:155], v[180:183], v[48:51]
    ds_read_b64 v[88:89], v250 offset:1152
    s_lshl_b32 s18, s16, 12
    v_mfma_f32_16x16x32_bf16 v[52:55], v[152:155], v[184:187], v[52:55]
    ds_read_b64 v[90:91], v250 offset:1160
    s_add_u32 s18, s18, 66560
    v_mfma_f32_16x16x32_bf16 v[48:51], v[144:147], v[188:191], v[48:51]
    ds_read_b128 v[124:127], v251 offset:2176
    v_add_u32 v242, s18, v242
    v_mfma_f32_16x16x32_bf16 v[52:55], v[148:151], v[188:191], v[52:55]
    ds_read_b64 v[92:93], v250 offset:1664
    v_readlane_b32 s74, v208, 0
    v_mfma_f32_16x16x32_bf16 v[56:59], v[152:155], v[188:191], v[56:59]
    ds_read_b64 v[94:95], v250 offset:1672
    v_readlane_b32 s75, v208, 1
    v_mfma_f32_16x16x32_bf16 v[48:51], v[156:159], v[176:179], v[48:51]
    ds_read_b128 v[128:131], v251 offset:1664
    v_readlane_b32 s76, v208, 2
    v_mfma_f32_16x16x32_bf16 v[52:55], v[156:159], v[180:183], v[52:55]
    ds_read_b64 v[96:97], v250 offset:2176
    v_readlane_b32 s77, v208, 3
    v_mfma_f32_16x16x32_bf16 v[56:59], v[156:159], v[184:187], v[56:59]
    ds_read_b64 v[98:99], v250 offset:2184
    v_readlane_b32 s78, v208, 4
    v_mfma_f32_16x16x32_bf16 v[60:63], v[156:159], v[188:191], v[60:63]
    ds_read_b128 v[132:135], v251 offset:1152
    v_readlane_b32 s79, v208, 5
    v_mfma_f32_16x16x32_bf16 v[52:55], v[144:147], v[192:195], v[52:55]
    ds_read_b64 v[100:101], v250 offset:2688
    v_readlane_b32 s80, v208, 6
    v_mfma_f32_16x16x32_bf16 v[56:59], v[148:151], v[192:195], v[56:59]
    ds_read_b64 v[102:103], v250 offset:2696
    v_readlane_b32 s81, v208, 7
    v_mfma_f32_16x16x32_bf16 v[60:63], v[152:155], v[192:195], v[60:63]
    ds_read_b128 v[136:139], v251 offset:640
    v_mfma_f32_16x16x32_bf16 v[64:67], v[156:159], v[192:195], v[64:67]
    ds_read_b64 v[104:105], v250 offset:3200
    v_mfma_f32_16x16x32_bf16 v[52:55], v[160:163], v[176:179], v[52:55]
    ds_read_b64 v[106:107], v250 offset:3208
    v_mfma_f32_16x16x32_bf16 v[56:59], v[160:163], v[180:183], v[56:59]
    ds_read_b128 v[140:143], v251 offset:128
    v_mfma_f32_16x16x32_bf16 v[60:63], v[160:163], v[184:187], v[60:63]
    ds_read_b64 v[108:109], v250 offset:3712
    v_mfma_f32_16x16x32_bf16 v[64:67], v[160:163], v[188:191], v[64:67]
    ds_read_b64 v[110:111], v250 offset:3720
    v_mfma_f32_16x16x32_bf16 v[56:59], v[144:147], v[196:199], v[56:59]
    v_mfma_f32_16x16x32_bf16 v[60:63], v[148:151], v[196:199], v[60:63]
    v_mfma_f32_16x16x32_bf16 v[64:67], v[152:155], v[196:199], v[64:67]
    v_mfma_f32_16x16x32_bf16 v[56:59], v[164:167], v[176:179], v[56:59]
    v_mfma_f32_16x16x32_bf16 v[60:63], v[164:167], v[180:183], v[60:63]
    v_mfma_f32_16x16x32_bf16 v[64:67], v[164:167], v[184:187], v[64:67]
    v_mfma_f32_16x16x32_bf16 v[60:63], v[144:147], v[200:203], v[60:63]
    v_mfma_f32_16x16x32_bf16 v[64:67], v[148:151], v[200:203], v[64:67]
    v_mfma_f32_16x16x32_bf16 v[60:63], v[168:171], v[176:179], v[60:63]
    v_mfma_f32_16x16x32_bf16 v[64:67], v[168:171], v[180:183], v[64:67]
    v_mfma_f32_16x16x32_bf16 v[64:67], v[144:147], v[204:207], v[64:67]
    v_mfma_f32_16x16x32_bf16 v[64:67], v[172:175], v[176:179], v[64:67]
    s_waitcnt lgkmcnt(0)
    v_mfma_f32_16x16x32_bf16 v[36:39], v[80:83], v[112:115], v[36:39]
    ds_read_b128 v[176:179], v251 offset:3776
    v_mfma_f32_16x16x32_bf16 v[40:43], v[80:83], v[116:119], v[40:43]
    ds_read_b64 v[144:145], v250 offset:192
    v_mfma_f32_16x16x32_bf16 v[40:43], v[84:87], v[112:115], v[40:43]
    ds_read_b64 v[146:147], v250 offset:200
    v_mfma_f32_16x16x32_bf16 v[44:47], v[84:87], v[116:119], v[44:47]
    ds_read_b128 v[180:183], v251 offset:3264
    v_mfma_f32_16x16x32_bf16 v[44:47], v[80:83], v[120:123], v[44:47]
    ds_read_b64 v[148:149], v250 offset:704
    v_mfma_f32_16x16x32_bf16 v[48:51], v[84:87], v[120:123], v[48:51]
    ds_read_b64 v[150:151], v250 offset:712
    v_mfma_f32_16x16x32_bf16 v[44:47], v[88:91], v[112:115], v[44:47]
    ds_read_b128 v[184:187], v251 offset:2752
    v_mfma_f32_16x16x32_bf16 v[48:51], v[88:91], v[116:119], v[48:51]
    ds_read_b64 v[152:153], v250 offset:1216
    v_mfma_f32_16x16x32_bf16 v[52:55], v[88:91], v[120:123], v[52:55]
    ds_read_b64 v[154:155], v250 offset:1224
    v_mfma_f32_16x16x32_bf16 v[48:51], v[80:83], v[124:127], v[48:51]
    ds_read_b128 v[188:191], v251 offset:2240
    v_mfma_f32_16x16x32_bf16 v[52:55], v[84:87], v[124:127], v[52:55]
    ds_read_b64 v[156:157], v250 offset:1728
    v_mfma_f32_16x16x32_bf16 v[56:59], v[88:91], v[124:127], v[56:59]
    ds_read_b64 v[158:159], v250 offset:1736
    v_mfma_f32_16x16x32_bf16 v[48:51], v[92:95], v[112:115], v[48:51]
    ds_read_b128 v[192:195], v251 offset:1728
    v_mfma_f32_16x16x32_bf16 v[52:55], v[92:95], v[116:119], v[52:55]
    ds_read_b64 v[160:161], v250 offset:2240
    v_mfma_f32_16x16x32_bf16 v[56:59], v[92:95], v[120:123], v[56:59]
    ds_read_b64 v[162:163], v250 offset:2248
    v_mfma_f32_16x16x32_bf16 v[60:63], v[92:95], v[124:127], v[60:63]
    ds_read_b128 v[196:199], v251 offset:1216
    v_mfma_f32_16x16x32_bf16 v[52:55], v[80:83], v[128:131], v[52:55]
    ds_read_b64 v[164:165], v250 offset:2752
    v_mfma_f32_16x16x32_bf16 v[56:59], v[84:87], v[128:131], v[56:59]
    ds_read_b64 v[166:167], v250 offset:2760
    v_mfma_f32_16x16x32_bf16 v[60:63], v[88:91], v[128:131], v[60:63]
    ds_read_b128 v[200:203], v251 offset:704
    v_mfma_f32_16x16x32_bf16 v[64:67], v[92:95], v[128:131], v[64:67]
    ds_read_b64 v[168:169], v250 offset:3264
    v_mfma_f32_16x16x32_bf16 v[52:55], v[96:99], v[112:115], v[52:55]
    ds_read_b64 v[170:171], v250 offset:3272
    v_mfma_f32_16x16x32_bf16 v[56:59], v[96:99], v[116:119], v[56:59]
    ds_read_b128 v[204:207], v251 offset:192
    v_mfma_f32_16x16x32_bf16 v[60:63], v[96:99], v[120:123], v[60:63]
    ds_read_b64 v[172:173], v250 offset:3776
    v_mfma_f32_16x16x32_bf16 v[64:67], v[96:99], v[124:127], v[64:67]
    ds_read_b64 v[174:175], v250 offset:3784
    v_mfma_f32_16x16x32_bf16 v[56:59], v[80:83], v[132:135], v[56:59]
    v_mfma_f32_16x16x32_bf16 v[60:63], v[84:87], v[132:135], v[60:63]
    v_mfma_f32_16x16x32_bf16 v[64:67], v[88:91], v[132:135], v[64:67]
    v_mfma_f32_16x16x32_bf16 v[56:59], v[100:103], v[112:115], v[56:59]
    v_mfma_f32_16x16x32_bf16 v[60:63], v[100:103], v[116:119], v[60:63]
    v_mfma_f32_16x16x32_bf16 v[64:67], v[100:103], v[120:123], v[64:67]
    v_mfma_f32_16x16x32_bf16 v[60:63], v[80:83], v[136:139], v[60:63]
    v_mfma_f32_16x16x32_bf16 v[64:67], v[84:87], v[136:139], v[64:67]
    v_mfma_f32_16x16x32_bf16 v[60:63], v[104:107], v[112:115], v[60:63]
    v_mfma_f32_16x16x32_bf16 v[64:67], v[104:107], v[116:119], v[64:67]
    v_mfma_f32_16x16x32_bf16 v[64:67], v[80:83], v[140:143], v[64:67]
    v_mfma_f32_16x16x32_bf16 v[64:67], v[108:111], v[112:115], v[64:67]
    s_waitcnt lgkmcnt(0)
    v_mfma_f32_16x16x32_bf16 v[36:39], v[144:147], v[176:179], v[36:39]
    v_mfma_f32_16x16x32_bf16 v[40:43], v[144:147], v[180:183], v[40:43]
    v_mfma_f32_16x16x32_bf16 v[40:43], v[148:151], v[176:179], v[40:43]
    v_mfma_f32_16x16x32_bf16 v[44:47], v[148:151], v[180:183], v[44:47]
    v_mfma_f32_16x16x32_bf16 v[44:47], v[144:147], v[184:187], v[44:47]
    v_mfma_f32_16x16x32_bf16 v[48:51], v[148:151], v[184:187], v[48:51]
    v_mfma_f32_16x16x32_bf16 v[44:47], v[152:155], v[176:179], v[44:47]
    v_mfma_f32_16x16x32_bf16 v[48:51], v[152:155], v[180:183], v[48:51]
    v_mfma_f32_16x16x32_bf16 v[52:55], v[152:155], v[184:187], v[52:55]
    s_waitcnt vmcnt(0)
    v_mfma_f32_16x16x32_bf16 v[48:51], v[144:147], v[188:191], v[48:51]
    ds_read_b64_tr_b16 v[80:81], v242 offset:0
    v_mfma_f32_16x16x32_bf16 v[52:55], v[148:151], v[188:191], v[52:55]
    ds_read_b64_tr_b16 v[82:83], v242 offset:1024
    v_mfma_f32_16x16x32_bf16 v[56:59], v[152:155], v[188:191], v[56:59]
    ds_read_b64_tr_b16 v[84:85], v242 offset:32
    v_mfma_f32_16x16x32_bf16 v[48:51], v[156:159], v[176:179], v[48:51]
    ds_read_b64_tr_b16 v[86:87], v242 offset:1056
    v_mfma_f32_16x16x32_bf16 v[52:55], v[156:159], v[180:183], v[52:55]
    ds_read_b64_tr_b16 v[88:89], v242 offset:64
    v_mfma_f32_16x16x32_bf16 v[56:59], v[156:159], v[184:187], v[56:59]
    ds_read_b64_tr_b16 v[90:91], v242 offset:1088
    v_mfma_f32_16x16x32_bf16 v[60:63], v[156:159], v[188:191], v[60:63]
    ds_read_b64_tr_b16 v[92:93], v242 offset:96
    v_mfma_f32_16x16x32_bf16 v[52:55], v[144:147], v[192:195], v[52:55]
    ds_read_b64_tr_b16 v[94:95], v242 offset:1120
    v_mfma_f32_16x16x32_bf16 v[56:59], v[148:151], v[192:195], v[56:59]
    s_waitcnt lgkmcnt(6)
    v_mfma_f32_16x16x32_bf16 v[60:63], v[152:155], v[192:195], v[60:63]
    buffer_store_dwordx4 v[80:83], v2, s[56:59], s74 offen sc1
    v_mfma_f32_16x16x32_bf16 v[64:67], v[156:159], v[192:195], v[64:67]
    s_waitcnt lgkmcnt(4)
    v_mfma_f32_16x16x32_bf16 v[52:55], v[160:163], v[176:179], v[52:55]
    buffer_store_dwordx4 v[84:87], v2, s[56:59], s75 offen sc1
    v_mfma_f32_16x16x32_bf16 v[56:59], v[160:163], v[180:183], v[56:59]
    s_waitcnt lgkmcnt(2)
    v_mfma_f32_16x16x32_bf16 v[60:63], v[160:163], v[184:187], v[60:63]
    buffer_store_dwordx4 v[88:91], v2, s[56:59], s76 offen sc1
    v_mfma_f32_16x16x32_bf16 v[64:67], v[160:163], v[188:191], v[64:67]
    s_waitcnt lgkmcnt(0)
    v_mfma_f32_16x16x32_bf16 v[56:59], v[144:147], v[196:199], v[56:59]
    buffer_store_dwordx4 v[92:95], v2, s[56:59], s77 offen sc1
    v_mfma_f32_16x16x32_bf16 v[60:63], v[148:151], v[196:199], v[60:63]
    v_mfma_f32_16x16x32_bf16 v[64:67], v[152:155], v[196:199], v[64:67]
    v_mfma_f32_16x16x32_bf16 v[56:59], v[164:167], v[176:179], v[56:59]
    v_mfma_f32_16x16x32_bf16 v[60:63], v[164:167], v[180:183], v[60:63]
    v_mfma_f32_16x16x32_bf16 v[64:67], v[164:167], v[184:187], v[64:67]
    v_mfma_f32_16x16x32_bf16 v[60:63], v[144:147], v[200:203], v[60:63]
    v_mfma_f32_16x16x32_bf16 v[64:67], v[148:151], v[200:203], v[64:67]
    v_mfma_f32_16x16x32_bf16 v[60:63], v[168:171], v[176:179], v[60:63]
    v_mfma_f32_16x16x32_bf16 v[64:67], v[168:171], v[180:183], v[64:67]
    v_mfma_f32_16x16x32_bf16 v[64:67], v[144:147], v[204:207], v[64:67]
    v_mfma_f32_16x16x32_bf16 v[64:67], v[172:175], v[176:179], v[64:67]
    s_add_u32 s44, s4, 0x3ec1000
    s_addc_u32 s45, s5, 0
    s_mov_b32 s46, 0x240000
    s_mov_b32 s47, 0x20000
    s_lshl_b32 s17, s16, 12
    s_add_u32 s17, s17, 66560
    v_add_u32 v192, s17, v2
    s_xor_b32 s17, s16, 4
    s_lshl_b32 s17, s17, 12
    s_add_u32 s17, s17, 66560
    v_add_u32 v193, s17, v2
    s_lshl_b32 s18, s66, 11
    s_mul_i32 s17, s65, 4576
    s_add_u32 s17, s17, 117880
    s_sub_u32 s17, s17, s18
    v_sub_u32 v194, s17, v252
    s_lshl_b32 s17, s65, 12
    s_add_u32 s17, s17, s18
    s_add_u32 s17, s17, 133632
    v_add_u32 v195, s17, v252
    s_mul_i32 s17, s65, 4160
    s_add_u32 s17, s17, s18
    v_add_u32 v196, s17, v252
    ds_read_b64 v[176:177], v194 offset:1536
    ds_read_b64 v[184:185], v195 offset:0
    ds_read_b64 v[178:179], v194 offset:1024
    ds_read_b64 v[186:187], v195 offset:512
    ds_read_b64 v[180:181], v194 offset:512
    ds_read_b64 v[188:189], v195 offset:1024
    ds_read_b64 v[182:183], v194 offset:0
    ds_read_b64 v[190:191], v195 offset:1536
    s_cmp_eq_u32 s66, 0
    s_cbranch_scc0 L_ab_x1
    ds_write_b128 v192, v[52:55] offset:0
    ds_write_b128 v192, v[56:59] offset:1024
    ds_write_b128 v192, v[60:63] offset:2048
    ds_write_b128 v192, v[64:67] offset:3072
    s_waitcnt lgkmcnt(0)
    s_barrier
    ds_read_b128 v[160:163], v193 offset:0
    ds_read_b128 v[164:167], v193 offset:1024
    ds_read_b128 v[168:171], v193 offset:2048
    ds_read_b128 v[172:175], v193 offset:3072
    s_waitcnt lgkmcnt(0)
    v_add_f32 v120, v36, v160
    v_add_f32 v121, v37, v161
    v_add_f32 v122, v38, v162
    v_add_f32 v123, v39, v163
    v_add_f32 v124, v40, v164
    v_add_f32 v125, v41, v165
    v_add_f32 v126, v42, v166
    v_add_f32 v127, v43, v167
    v_add_f32 v128, v44, v168
    v_add_f32 v129, v45, v169
    v_add_f32 v130, v46, v170
    v_add_f32 v131, v47, v171
    v_add_f32 v132, v48, v172
    v_add_f32 v133, v49, v173
    v_add_f32 v134, v50, v174
    v_add_f32 v135, v51, v175
    s_branch L_ab_x2
L_ab_x1:
    ds_write_b128 v192, v[36:39] offset:0
    ds_write_b128 v192, v[40:43] offset:1024
    ds_write_b128 v192, v[44:47] offset:2048
    ds_write_b128 v192, v[48:51] offset:3072
    s_waitcnt lgkmcnt(0)
    s_barrier
    ds_read_b128 v[160:163], v193 offset:0
    ds_read_b128 v[164:167], v193 offset:1024
    ds_read_b128 v[168:171], v193 offset:2048
    ds_read_b128 v[172:175], v193 offset:3072
    s_waitcnt lgkmcnt(0)
    v_add_f32 v120, v52, v160
    v_add_f32 v121, v53, v161
    v_add_f32 v122, v54, v162
    v_add_f32 v123, v55, v163
    v_add_f32 v124, v56, v164
    v_add_f32 v125, v57, v165
    v_add_f32 v126, v58, v166
    v_add_f32 v127, v59, v167
    v_add_f32 v128, v60, v168
    v_add_f32 v129, v61, v169
    v_add_f32 v130, v62, v170
    v_add_f32 v131, v63, v171
    v_add_f32 v132, v64, v172
    v_add_f32 v133, v65, v173
    v_add_f32 v134, v66, v174
    v_add_f32 v135, v67, v175
L_ab_x2:
    v_and_b32 v136, 0xffff0000, v177
    v_lshlrev_b32 v137, 16, v177
    v_and_b32 v138, 0xffff0000, v176
    v_lshlrev_b32 v139, 16, v176
    v_lshlrev_b32 v140, 16, v184
    v_and_b32 v141, 0xffff0000, v184
    v_lshlrev_b32 v142, 16, v185
    v_and_b32 v143, 0xffff0000, v185
    v_fma_f32 v136, v136, s30, v120
    v_fma_f32 v137, v137, s30, v121
    v_fma_f32 v138, v138, s30, v122
    v_fma_f32 v139, v139, s30, v123
    v_fma_f32 v140, v136, s28, v140
    v_fma_f32 v141, v137, s28, v141
    v_fma_f32 v142, v138, s28, v142
    v_fma_f32 v143, v139, s28, v143
    v_cvt_pk_bf16_f32 v144, v140, v141
    v_cvt_pk_bf16_f32 v145, v142, v143
    ds_write_b64 v196, v[144:145] offset:0
    v_and_b32 v148, 0xffff0000, v179
    v_lshlrev_b32 v149, 16, v179
    v_and_b32 v150, 0xffff0000, v178
    v_lshlrev_b32 v151, 16, v178
    v_lshlrev_b32 v152, 16, v186
    v_and_b32 v153, 0xffff0000, v186
    v_lshlrev_b32 v154, 16, v187
    v_and_b32 v155, 0xffff0000, v187
    v_fma_f32 v148, v148, s30, v124
    v_fma_f32 v149, v149, s30, v125
    v_fma_f32 v150, v150, s30, v126
    v_fma_f32 v151, v151, s30, v127
    v_fma_f32 v152, v148, s28, v152
    v_fma_f32 v153, v149, s28, v153
    v_fma_f32 v154, v150, s28, v154
    v_fma_f32 v155, v151, s28, v155
    v_cvt_pk_bf16_f32 v156, v152, v153
    v_cvt_pk_bf16_f32 v157, v154, v155
    ds_write_b64 v196, v[156:157] offset:512
    v_and_b32 v136, 0xffff0000, v181
    v_lshlrev_b32 v137, 16, v181
    v_and_b32 v138, 0xffff0000, v180
    v_lshlrev_b32 v139, 16, v180
    v_lshlrev_b32 v140, 16, v188
    v_and_b32 v141, 0xffff0000, v188
    v_lshlrev_b32 v142, 16, v189
    v_and_b32 v143, 0xffff0000, v189
    v_fma_f32 v136, v136, s30, v128
    v_fma_f32 v137, v137, s30, v129
    v_fma_f32 v138, v138, s30, v130
    v_fma_f32 v139, v139, s30, v131
    v_fma_f32 v140, v136, s28, v140
    v_fma_f32 v141, v137, s28, v141
    v_fma_f32 v142, v138, s28, v142
    v_fma_f32 v143, v139, s28, v143
    v_cvt_pk_bf16_f32 v144, v140, v141
    v_cvt_pk_bf16_f32 v145, v142, v143
    ds_write_b64 v196, v[144:145] offset:1024
    v_and_b32 v148, 0xffff0000, v183
    v_lshlrev_b32 v149, 16, v183
    v_and_b32 v150, 0xffff0000, v182
    v_lshlrev_b32 v151, 16, v182
    v_lshlrev_b32 v152, 16, v190
    v_and_b32 v153, 0xffff0000, v190
    v_lshlrev_b32 v154, 16, v191
    v_and_b32 v155, 0xffff0000, v191
    v_fma_f32 v148, v148, s30, v132
    v_fma_f32 v149, v149, s30, v133
    v_fma_f32 v150, v150, s30, v134
    v_fma_f32 v151, v151, s30, v135
    v_fma_f32 v152, v148, s28, v152
    v_fma_f32 v153, v149, s28, v153
    v_fma_f32 v154, v150, s28, v154
    v_fma_f32 v155, v151, s28, v155
    v_cvt_pk_bf16_f32 v156, v152, v153
    v_cvt_pk_bf16_f32 v157, v154, v155
    ds_write_b64 v196, v[156:157] offset:1536
    v_bfe_u32 v197, v1, 2, 2
    v_mul_u32_u24 v197, 4160, v197
    v_lshrrev_b32 v4, 4, v1
    v_lshl_add_u32 v197, v4, 5, v197
    v_and_b32 v4, 3, v1
    v_lshl_add_u32 v197, v4, 3, v197
    s_lshl_b32 s17, s16, 9
    v_add_u32 v197, s17, v197
    v_lshlrev_b32 v198, 3, v1
    s_lshl_b32 s17, s64, 14
    s_lshl_b32 s18, s16, 11
    s_add_u32 s17, s17, s18
    s_waitcnt lgkmcnt(0)
    s_barrier
    ds_read_b64_tr_b16 v[160:161], v197 offset:0
    ds_read_b64_tr_b16 v[162:163], v197 offset:128
    ds_read_b64_tr_b16 v[164:165], v197 offset:256
    ds_read_b64_tr_b16 v[166:167], v197 offset:384
    s_waitcnt lgkmcnt(3)
    buffer_store_dwordx2 v[160:161], v198, s[44:47], s17 offen offset:0 sc1
    s_waitcnt lgkmcnt(2)
    buffer_store_dwordx2 v[162:163], v198, s[44:47], s17 offen offset:512 sc1
    s_waitcnt lgkmcnt(1)
    buffer_store_dwordx2 v[164:165], v198, s[44:47], s17 offen offset:1024 sc1
    s_waitcnt lgkmcnt(0)
    buffer_store_dwordx2 v[166:167], v198, s[44:47], s17 offen offset:1536 sc1
    s_cmp_lg_u32 s16, 0
    s_cbranch_scc1 L_ab_u8b
    ds_read_b64_tr_b16 v[96:97], v242 offset:32768
    ds_read_b64_tr_b16 v[98:99], v242 offset:33792
    ds_read_b64_tr_b16 v[100:101], v242 offset:32800
    ds_read_b64_tr_b16 v[102:103], v242 offset:33824
    ds_read_b64_tr_b16 v[104:105], v242 offset:32832
    ds_read_b64_tr_b16 v[106:107], v242 offset:33856
    ds_read_b64_tr_b16 v[108:109], v242 offset:32864
    ds_read_b64_tr_b16 v[110:111], v242 offset:33888
    s_waitcnt lgkmcnt(6)
    buffer_store_dwordx4 v[96:99], v2, s[56:59], s78 offen sc1
    s_waitcnt lgkmcnt(4)
    buffer_store_dwordx4 v[100:103], v2, s[56:59], s79 offen sc1
    s_waitcnt lgkmcnt(2)
    buffer_store_dwordx4 v[104:107], v2, s[56:59], s80 offen sc1
    s_waitcnt lgkmcnt(0)
    buffer_store_dwordx4 v[108:111], v2, s[56:59], s81 offen sc1
L_ab_u8b:
    s_endpgm
L_ab_gb:
    v_lshrrev_b32 v30, 4, v0
    v_lshlrev_b32 v30, 8, v30
    v_lshl_add_u32 v30, v27, 5, v30
    v_add_u32 v30, 151552, v30
    s_waitcnt vmcnt(10)
    v_lshlrev_b32 v31, 16, v31
    v_lshlrev_b32 v32, 16, v32
    v_lshlrev_b32 v33, 16, v33
    v_lshlrev_b32 v34, 16, v34
    v_lshlrev_b32 v35, 16, v35
    v_lshlrev_b32 v36, 16, v36
    v_lshlrev_b32 v37, 16, v37
    v_lshlrev_b32 v38, 16, v38
    v_lshlrev_b32 v39, 16, v39
    v_mul_f32 v40, 0xbfb8aa3b, v31
    v_mul_f32 v41, 0xbfb8aa3b, v32
    v_mul_f32 v42, 0xbfb8aa3b, v33
    v_mul_f32 v43, 0xbfb8aa3b, v34
    v_mul_f32 v44, 0xbfb8aa3b, v35
    v_mul_f32 v45, 0xbfb8aa3b, v36
    v_mul_f32 v46, 0xbfb8aa3b, v37
    v_mul_f32 v47, 0xbfb8aa3b, v38
    v_mul_f32 v48, 0xbfb8aa3b, v39
    v_exp_f32 v40, v40
    v_exp_f32 v41, v41
    v_exp_f32 v42, v42
    v_exp_f32 v43, v43
    v_exp_f32 v44, v44
    v_exp_f32 v45, v45
    v_exp_f32 v46, v46
    v_exp_f32 v47, v47
    v_exp_f32 v48, v48
    v_add_f32 v40, 1.0, v40
    v_add_f32 v41, 1.0, v41
    v_add_f32 v42, 1.0, v42
    v_add_f32 v43, 1.0, v43
    v_add_f32 v44, 1.0, v44
    v_add_f32 v45, 1.0, v45
    v_add_f32 v46, 1.0, v46
    v_add_f32 v47, 1.0, v47
    v_add_f32 v48, 1.0, v48
    v_rcp_f32 v40, v40
    v_rcp_f32 v41, v41
    v_rcp_f32 v42, v42
    v_rcp_f32 v43, v43
    v_rcp_f32 v44, v44
    v_rcp_f32 v45, v45
    v_rcp_f32 v46, v46
    v_rcp_f32 v47, v47
    v_rcp_f32 v48, v48
    v_mul_f32 v31, v31, v40
    v_mul_f32 v32, v32, v41
    v_mul_f32 v33, v33, v42
    v_mul_f32 v34, v34, v43
    v_mul_f32 v35, v35, v44
    v_mul_f32 v36, v36, v45
    v_mul_f32 v37, v37, v46
    v_mul_f32 v38, v38, v47
    v_mul_f32 v39, v39, v48
    v_cvt_pk_bf16_f32 v31, v31, v31
    v_cvt_pk_bf16_f32 v32, v32, v32
    v_cvt_pk_bf16_f32 v33, v33, v33
    v_cvt_pk_bf16_f32 v34, v34, v34
    v_cvt_pk_bf16_f32 v35, v35, v35
    v_cvt_pk_bf16_f32 v36, v36, v36
    v_cvt_pk_bf16_f32 v37, v37, v37
    v_cvt_pk_bf16_f32 v38, v38, v38
    v_cvt_pk_bf16_f32 v39, v39, v39
    v_and_b32 v31, 0xffff0000, v31
    v_and_b32 v32, 0xffff0000, v32
    v_and_b32 v33, 0xffff0000, v33
    v_and_b32 v34, 0xffff0000, v34
    v_and_b32 v35, 0xffff0000, v35
    v_and_b32 v36, 0xffff0000, v36
    v_and_b32 v37, 0xffff0000, v37
    v_and_b32 v38, 0xffff0000, v38
    v_and_b32 v39, 0xffff0000, v39
    s_waitcnt vmcnt(9)
    v_lshlrev_b32 v49, 16, v64
    v_and_b32 v50, 0xffff0000, v64
    v_mul_f32 v56, v31, v49
    v_mul_f32 v57, v31, v50
    v_lshlrev_b32 v51, 16, v65
    v_and_b32 v52, 0xffff0000, v65
    v_mul_f32 v58, v31, v51
    v_mul_f32 v59, v31, v52
    v_lshlrev_b32 v49, 16, v66
    v_and_b32 v50, 0xffff0000, v66
    v_mul_f32 v60, v31, v49
    v_mul_f32 v61, v31, v50
    v_lshlrev_b32 v51, 16, v67
    v_and_b32 v52, 0xffff0000, v67
    v_mul_f32 v62, v31, v51
    v_mul_f32 v63, v31, v52
    s_waitcnt vmcnt(8)
    v_lshlrev_b32 v49, 16, v68
    v_and_b32 v50, 0xffff0000, v68
    v_fmac_f32 v56, v32, v49
    v_fmac_f32 v57, v32, v50
    v_lshlrev_b32 v51, 16, v69
    v_and_b32 v52, 0xffff0000, v69
    v_fmac_f32 v58, v32, v51
    v_fmac_f32 v59, v32, v52
    v_lshlrev_b32 v49, 16, v70
    v_and_b32 v50, 0xffff0000, v70
    v_fmac_f32 v60, v32, v49
    v_fmac_f32 v61, v32, v50
    v_lshlrev_b32 v51, 16, v71
    v_and_b32 v52, 0xffff0000, v71
    v_fmac_f32 v62, v32, v51
    v_fmac_f32 v63, v32, v52
    s_waitcnt vmcnt(7)
    v_lshlrev_b32 v49, 16, v72
    v_and_b32 v50, 0xffff0000, v72
    v_fmac_f32 v56, v33, v49
    v_fmac_f32 v57, v33, v50
    v_lshlrev_b32 v51, 16, v73
    v_and_b32 v52, 0xffff0000, v73
    v_fmac_f32 v58, v33, v51
    v_fmac_f32 v59, v33, v52
    v_lshlrev_b32 v49, 16, v74
    v_and_b32 v50, 0xffff0000, v74
    v_fmac_f32 v60, v33, v49
    v_fmac_f32 v61, v33, v50
    v_lshlrev_b32 v51, 16, v75
    v_and_b32 v52, 0xffff0000, v75
    v_fmac_f32 v62, v33, v51
    v_fmac_f32 v63, v33, v52
    s_waitcnt vmcnt(6)
    v_lshlrev_b32 v49, 16, v76
    v_and_b32 v50, 0xffff0000, v76
    v_fmac_f32 v56, v34, v49
    v_fmac_f32 v57, v34, v50
    v_lshlrev_b32 v51, 16, v77
    v_and_b32 v52, 0xffff0000, v77
    v_fmac_f32 v58, v34, v51
    v_fmac_f32 v59, v34, v52
    v_lshlrev_b32 v49, 16, v78
    v_and_b32 v50, 0xffff0000, v78
    v_fmac_f32 v60, v34, v49
    v_fmac_f32 v61, v34, v50
    v_lshlrev_b32 v51, 16, v79
    v_and_b32 v52, 0xffff0000, v79
    v_fmac_f32 v62, v34, v51
    v_fmac_f32 v63, v34, v52
    s_waitcnt vmcnt(5)
    v_lshlrev_b32 v49, 16, v80
    v_and_b32 v50, 0xffff0000, v80
    v_fmac_f32 v56, v35, v49
    v_fmac_f32 v57, v35, v50
    v_lshlrev_b32 v51, 16, v81
    v_and_b32 v52, 0xffff0000, v81
    v_fmac_f32 v58, v35, v51
    v_fmac_f32 v59, v35, v52
    v_lshlrev_b32 v49, 16, v82
    v_and_b32 v50, 0xffff0000, v82
    v_fmac_f32 v60, v35, v49
    v_fmac_f32 v61, v35, v50
    v_lshlrev_b32 v51, 16, v83
    v_and_b32 v52, 0xffff0000, v83
    v_fmac_f32 v62, v35, v51
    v_fmac_f32 v63, v35, v52
    s_waitcnt vmcnt(4)
    v_lshlrev_b32 v49, 16, v84
    v_and_b32 v50, 0xffff0000, v84
    v_fmac_f32 v56, v36, v49
    v_fmac_f32 v57, v36, v50
    v_lshlrev_b32 v51, 16, v85
    v_and_b32 v52, 0xffff0000, v85
    v_fmac_f32 v58, v36, v51
    v_fmac_f32 v59, v36, v52
    v_lshlrev_b32 v49, 16, v86
    v_and_b32 v50, 0xffff0000, v86
    v_fmac_f32 v60, v36, v49
    v_fmac_f32 v61, v36, v50
    v_lshlrev_b32 v51, 16, v87
    v_and_b32 v52, 0xffff0000, v87
    v_fmac_f32 v62, v36, v51
    v_fmac_f32 v63, v36, v52
    s_waitcnt vmcnt(3)
    v_lshlrev_b32 v49, 16, v88
    v_and_b32 v50, 0xffff0000, v88
    v_fmac_f32 v56, v37, v49
    v_fmac_f32 v57, v37, v50
    v_lshlrev_b32 v51, 16, v89
    v_and_b32 v52, 0xffff0000, v89
    v_fmac_f32 v58, v37, v51
    v_fmac_f32 v59, v37, v52
    v_lshlrev_b32 v49, 16, v90
    v_and_b32 v50, 0xffff0000, v90
    v_fmac_f32 v60, v37, v49
    v_fmac_f32 v61, v37, v50
    v_lshlrev_b32 v51, 16, v91
    v_and_b32 v52, 0xffff0000, v91
    v_fmac_f32 v62, v37, v51
    v_fmac_f32 v63, v37, v52
    s_waitcnt vmcnt(2)
    v_lshlrev_b32 v49, 16, v92
    v_and_b32 v50, 0xffff0000, v92
    v_fmac_f32 v56, v38, v49
    v_fmac_f32 v57, v38, v50
    v_lshlrev_b32 v51, 16, v93
    v_and_b32 v52, 0xffff0000, v93
    v_fmac_f32 v58, v38, v51
    v_fmac_f32 v59, v38, v52
    v_lshlrev_b32 v49, 16, v94
    v_and_b32 v50, 0xffff0000, v94
    v_fmac_f32 v60, v38, v49
    v_fmac_f32 v61, v38, v50
    v_lshlrev_b32 v51, 16, v95
    v_and_b32 v52, 0xffff0000, v95
    v_fmac_f32 v62, v38, v51
    v_fmac_f32 v63, v38, v52
    s_waitcnt vmcnt(1)
    v_lshlrev_b32 v49, 16, v96
    v_and_b32 v50, 0xffff0000, v96
    v_fmac_f32 v56, v39, v49
    v_fmac_f32 v57, v39, v50
    v_lshlrev_b32 v51, 16, v97
    v_and_b32 v52, 0xffff0000, v97
    v_fmac_f32 v58, v39, v51
    v_fmac_f32 v59, v39, v52
    v_lshlrev_b32 v49, 16, v98
    v_and_b32 v50, 0xffff0000, v98
    v_fmac_f32 v60, v39, v49
    v_fmac_f32 v61, v39, v50
    v_lshlrev_b32 v51, 16, v99
    v_and_b32 v52, 0xffff0000, v99
    v_fmac_f32 v62, v39, v51
    v_fmac_f32 v63, v39, v52
    buffer_load_dwordx2 v[24:25], off, s[12:15], 0 sc1
    v_add_f32_dpp v56, v56, v56 row_ror:8 row_mask:0xf bank_mask:0xf
    v_add_f32_dpp v57, v57, v57 row_ror:8 row_mask:0xf bank_mask:0xf
    v_add_f32_dpp v58, v58, v58 row_ror:8 row_mask:0xf bank_mask:0xf
    v_add_f32_dpp v59, v59, v59 row_ror:8 row_mask:0xf bank_mask:0xf
    v_add_f32_dpp v60, v60, v60 row_ror:8 row_mask:0xf bank_mask:0xf
    v_add_f32_dpp v61, v61, v61 row_ror:8 row_mask:0xf bank_mask:0xf
    v_add_f32_dpp v62, v62, v62 row_ror:8 row_mask:0xf bank_mask:0xf
    v_add_f32_dpp v63, v63, v63 row_ror:8 row_mask:0xf bank_mask:0xf
    ds_write_b128 v30, v[56:59]
    ds_write_b128 v30, v[60:63] offset:16
    v_mov_b32 v4, 155648
    v_mov_b32 v5, 1
    s_mov_b64 exec, 1
    s_waitcnt lgkmcnt(0)
    ds_add_rtn_u32 v5, v4, v5
    s_waitcnt lgkmcnt(0)
    v_readfirstlane_b32 s17, v5
    s_mov_b64 exec, -1
    s_cmp_lg_u32 s17, 3
    s_cbranch_scc1 L_ab_b1
    v_lshlrev_b32 v30, 2, v1
    v_add_u32 v29, 151552, v30
    ds_read_b32 v64, v29 offset:0
    ds_read_b32 v65, v29 offset:256
    ds_read_b32 v66, v29 offset:512
    ds_read_b32 v67, v29 offset:768
    ds_read_b32 v68, v29 offset:1024
    ds_read_b32 v69, v29 offset:1280
    ds_read_b32 v70, v29 offset:1536
    ds_read_b32 v71, v29 offset:1792
    ds_read_b32 v72, v29 offset:2048
    ds_read_b32 v73, v29 offset:2304
    ds_read_b32 v74, v29 offset:2560
    ds_read_b32 v75, v29 offset:2816
    ds_read_b32 v76, v29 offset:3072
    ds_read_b32 v77, v29 offset:3328
    ds_read_b32 v78, v29 offset:3584
    ds_read_b32 v79, v29 offset:3840
    s_add_u32 s36, s4, 0x3ea5000
    s_addc_u32 s37, s5, 0
    s_mov_b32 s38, 0x1b000
    s_mov_b32 s39, 0x20000
    s_waitcnt lgkmcnt(0)
    v_add_f32 v64, v64, v72
    v_add_f32 v65, v65, v73
    v_add_f32 v66, v66, v74
    v_add_f32 v67, v67, v75
    v_add_f32 v68, v68, v76
    v_add_f32 v69, v69, v77
    v_add_f32 v70, v70, v78
    v_add_f32 v71, v71, v79
    v_add_f32 v64, v64, v68
    v_add_f32 v65, v65, v69
    v_add_f32 v66, v66, v70
    v_add_f32 v67, v67, v71
    v_add_f32 v64, v64, v66
    v_add_f32 v65, v65, v67
    v_add_f32 v80, v64, v65
    s_waitcnt vmcnt(0)
    v_readfirstlane_b32 s8, v24
    v_readfirstlane_b32 s9, v25
    v_mov_b32 v81, 0
    s_cmp_lg_u64 s[8:9], 0
    s_cbranch_scc1 L_ab_kernel_tg_8
L_ab_kernel_gt_9:
    buffer_load_dwordx2 v[24:25], off, s[12:15], 0 sc1
    s_waitcnt vmcnt(0)
    v_readfirstlane_b32 s8, v24
    v_readfirstlane_b32 s9, v25
    s_nop 0
    s_cmp_lg_u64 s[8:9], 0
    s_cbranch_scc1 L_ab_kernel_gt_9x
    s_sleep 8
    s_sub_u32 s3, s3, 1
    s_cbranch_scc0 L_ab_kernel_gt_9
L_ab_kernel_gt_9x:
L_ab_kernel_tg_8:
    v_mov_b32 v82, s8
    v_mov_b32 v83, s9
    s_lshl_b32 s17, s52, 10
    s_mul_i32 s18, s56, 55296
    s_add_u32 s17, s17, s18
    buffer_store_dwordx4 v[80:83], v2, s[36:39], s17 offen sc1
    s_branch L_ab_b1
L_ab_stb:
    v_lshlrev_b32 v32, 4, v32
    s_waitcnt vmcnt(9)
    buffer_load_dwordx2 v[24:25], off, s[12:15], 0 sc1
    v_lshlrev_b32 v76, 16, v40
    v_and_b32 v77, 0xffff0000, v40
    v_lshlrev_b32 v78, 16, v41
    v_and_b32 v79, 0xffff0000, v41
    v_lshlrev_b32 v80, 16, v42
    v_and_b32 v81, 0xffff0000, v42
    v_lshlrev_b32 v82, 16, v43
    v_and_b32 v83, 0xffff0000, v43
    v_mov_b32 v35, v76
    v_mul_f32 v152, v76, v76
    v_mov_b32 v36, v77
    v_mul_f32 v153, v77, v77
    v_add_f32 v35, v35, v78
    v_fmac_f32 v152, v78, v78
    v_add_f32 v36, v36, v79
    v_fmac_f32 v153, v79, v79
    v_add_f32 v35, v35, v80
    v_fmac_f32 v152, v80, v80
    v_add_f32 v36, v36, v81
    v_fmac_f32 v153, v81, v81
    v_add_f32 v35, v35, v82
    v_fmac_f32 v152, v82, v82
    v_add_f32 v36, v36, v83
    v_fmac_f32 v153, v83, v83
    s_waitcnt vmcnt(9)
    v_lshlrev_b32 v84, 16, v44
    v_and_b32 v85, 0xffff0000, v44
    v_lshlrev_b32 v86, 16, v45
    v_and_b32 v87, 0xffff0000, v45
    v_lshlrev_b32 v88, 16, v46
    v_and_b32 v89, 0xffff0000, v46
    v_lshlrev_b32 v90, 16, v47
    v_and_b32 v91, 0xffff0000, v47
    v_add_f32 v35, v35, v84
    v_fmac_f32 v152, v84, v84
    v_add_f32 v36, v36, v85
    v_fmac_f32 v153, v85, v85
    v_add_f32 v35, v35, v86
    v_fmac_f32 v152, v86, v86
    v_add_f32 v36, v36, v87
    v_fmac_f32 v153, v87, v87
    v_add_f32 v35, v35, v88
    v_fmac_f32 v152, v88, v88
    v_add_f32 v36, v36, v89
    v_fmac_f32 v153, v89, v89
    v_add_f32 v35, v35, v90
    v_fmac_f32 v152, v90, v90
    v_add_f32 v36, v36, v91
    v_fmac_f32 v153, v91, v91
    s_waitcnt vmcnt(8)
    v_lshlrev_b32 v92, 16, v48
    v_and_b32 v93, 0xffff0000, v48
    v_lshlrev_b32 v94, 16, v49
    v_and_b32 v95, 0xffff0000, v49
    v_lshlrev_b32 v96, 16, v50
    v_and_b32 v97, 0xffff0000, v50
    v_lshlrev_b32 v98, 16, v51
    v_and_b32 v99, 0xffff0000, v51
    v_add_f32 v35, v35, v92
    v_fmac_f32 v152, v92, v92
    v_add_f32 v36, v36, v93
    v_fmac_f32 v153, v93, v93
    v_add_f32 v35, v35, v94
    v_fmac_f32 v152, v94, v94
    v_add_f32 v36, v36, v95
    v_fmac_f32 v153, v95, v95
    v_add_f32 v35, v35, v96
    v_fmac_f32 v152, v96, v96
    v_add_f32 v36, v36, v97
    v_fmac_f32 v153, v97, v97
    v_add_f32 v35, v35, v98
    v_fmac_f32 v152, v98, v98
    v_add_f32 v36, v36, v99
    v_fmac_f32 v153, v99, v99
    s_waitcnt vmcnt(7)
    v_lshlrev_b32 v100, 16, v52
    v_and_b32 v101, 0xffff0000, v52
    v_lshlrev_b32 v102, 16, v53
    v_and_b32 v103, 0xffff0000, v53
    v_lshlrev_b32 v104, 16, v54
    v_and_b32 v105, 0xffff0000, v54
    v_lshlrev_b32 v106, 16, v55
    v_and_b32 v107, 0xffff0000, v55
    v_add_f32 v35, v35, v100
    v_fmac_f32 v152, v100, v100
    v_add_f32 v36, v36, v101
    v_fmac_f32 v153, v101, v101
    v_add_f32 v35, v35, v102
    v_fmac_f32 v152, v102, v102
    v_add_f32 v36, v36, v103
    v_fmac_f32 v153, v103, v103
    v_add_f32 v35, v35, v104
    v_fmac_f32 v152, v104, v104
    v_add_f32 v36, v36, v105
    v_fmac_f32 v153, v105, v105
    v_add_f32 v35, v35, v106
    v_fmac_f32 v152, v106, v106
    v_add_f32 v36, v36, v107
    v_fmac_f32 v153, v107, v107
    s_waitcnt vmcnt(6)
    v_lshlrev_b32 v108, 16, v56
    v_and_b32 v109, 0xffff0000, v56
    v_lshlrev_b32 v110, 16, v57
    v_and_b32 v111, 0xffff0000, v57
    v_lshlrev_b32 v112, 16, v58
    v_and_b32 v113, 0xffff0000, v58
    v_lshlrev_b32 v114, 16, v59
    v_and_b32 v115, 0xffff0000, v59
    v_add_f32 v35, v35, v108
    v_fmac_f32 v152, v108, v108
    v_add_f32 v36, v36, v109
    v_fmac_f32 v153, v109, v109
    v_add_f32 v35, v35, v110
    v_fmac_f32 v152, v110, v110
    v_add_f32 v36, v36, v111
    v_fmac_f32 v153, v111, v111
    v_add_f32 v35, v35, v112
    v_fmac_f32 v152, v112, v112
    v_add_f32 v36, v36, v113
    v_fmac_f32 v153, v113, v113
    v_add_f32 v35, v35, v114
    v_fmac_f32 v152, v114, v114
    v_add_f32 v36, v36, v115
    v_fmac_f32 v153, v115, v115
    s_waitcnt vmcnt(5)
    v_lshlrev_b32 v116, 16, v60
    v_and_b32 v117, 0xffff0000, v60
    v_lshlrev_b32 v118, 16, v61
    v_and_b32 v119, 0xffff0000, v61
    v_lshlrev_b32 v120, 16, v62
    v_and_b32 v121, 0xffff0000, v62
    v_lshlrev_b32 v122, 16, v63
    v_and_b32 v123, 0xffff0000, v63
    v_add_f32 v35, v35, v116
    v_fmac_f32 v152, v116, v116
    v_add_f32 v36, v36, v117
    v_fmac_f32 v153, v117, v117
    v_add_f32 v35, v35, v118
    v_fmac_f32 v152, v118, v118
    v_add_f32 v36, v36, v119
    v_fmac_f32 v153, v119, v119
    v_add_f32 v35, v35, v120
    v_fmac_f32 v152, v120, v120
    v_add_f32 v36, v36, v121
    v_fmac_f32 v153, v121, v121
    v_add_f32 v35, v35, v122
    v_fmac_f32 v152, v122, v122
    v_add_f32 v36, v36, v123
    v_fmac_f32 v153, v123, v123
    s_waitcnt vmcnt(4)
    v_lshlrev_b32 v124, 16, v64
    v_and_b32 v125, 0xffff0000, v64
    v_lshlrev_b32 v126, 16, v65
    v_and_b32 v127, 0xffff0000, v65
    v_lshlrev_b32 v128, 16, v66
    v_and_b32 v129, 0xffff0000, v66
    v_lshlrev_b32 v130, 16, v67
    v_and_b32 v131, 0xffff0000, v67
    v_add_f32 v35, v35, v124
    v_fmac_f32 v152, v124, v124
    v_add_f32 v36, v36, v125
    v_fmac_f32 v153, v125, v125
    v_add_f32 v35, v35, v126
    v_fmac_f32 v152, v126, v126
    v_add_f32 v36, v36, v127
    v_fmac_f32 v153, v127, v127
    v_add_f32 v35, v35, v128
    v_fmac_f32 v152, v128, v128
    v_add_f32 v36, v36, v129
    v_fmac_f32 v153, v129, v129
    v_add_f32 v35, v35, v130
    v_fmac_f32 v152, v130, v130
    v_add_f32 v36, v36, v131
    v_fmac_f32 v153, v131, v131
    s_waitcnt vmcnt(3)
    v_lshlrev_b32 v132, 16, v68
    v_and_b32 v133, 0xffff0000, v68
    v_lshlrev_b32 v134, 16, v69
    v_and_b32 v135, 0xffff0000, v69
    v_lshlrev_b32 v136, 16, v70
    v_and_b32 v137, 0xffff0000, v70
    v_lshlrev_b32 v138, 16, v71
    v_and_b32 v139, 0xffff0000, v71
    v_add_f32 v35, v35, v132
    v_fmac_f32 v152, v132, v132
    v_add_f32 v36, v36, v133
    v_fmac_f32 v153, v133, v133
    v_add_f32 v35, v35, v134
    v_fmac_f32 v152, v134, v134
    v_add_f32 v36, v36, v135
    v_fmac_f32 v153, v135, v135
    v_add_f32 v35, v35, v136
    v_fmac_f32 v152, v136, v136
    v_add_f32 v36, v36, v137
    v_fmac_f32 v153, v137, v137
    v_add_f32 v35, v35, v138
    v_fmac_f32 v152, v138, v138
    v_add_f32 v36, v36, v139
    v_fmac_f32 v153, v139, v139
    s_waitcnt vmcnt(2)
    v_lshlrev_b32 v140, 16, v72
    v_and_b32 v141, 0xffff0000, v72
    v_lshlrev_b32 v142, 16, v73
    v_and_b32 v143, 0xffff0000, v73
    v_lshlrev_b32 v144, 16, v74
    v_and_b32 v145, 0xffff0000, v74
    v_lshlrev_b32 v146, 16, v75
    v_and_b32 v147, 0xffff0000, v75
    v_add_f32 v35, v35, v140
    v_fmac_f32 v152, v140, v140
    v_add_f32 v36, v36, v141
    v_fmac_f32 v153, v141, v141
    v_add_f32 v35, v35, v142
    v_fmac_f32 v152, v142, v142
    v_add_f32 v36, v36, v143
    v_fmac_f32 v153, v143, v143
    v_add_f32 v35, v35, v144
    v_fmac_f32 v152, v144, v144
    v_add_f32 v36, v36, v145
    v_fmac_f32 v153, v145, v145
    v_add_f32 v35, v35, v146
    v_fmac_f32 v152, v146, v146
    v_add_f32 v36, v36, v147
    v_fmac_f32 v153, v147, v147
    v_add_f32 v36, v35, v36
    v_add_f32 v35, v152, v153
    s_nop 0
    v_add_f32_dpp v36, v36, v36 quad_perm:[1,0,3,2] row_mask:0xf bank_mask:0xf
    s_nop 1
    v_add_f32_dpp v36, v36, v36 quad_perm:[2,3,0,1] row_mask:0xf bank_mask:0xf
    s_nop 1
    v_add_f32_dpp v36, v36, v36 row_half_mirror row_mask:0xf bank_mask:0xf
    v_add_f32_dpp v35, v35, v35 quad_perm:[1,0,3,2] row_mask:0xf bank_mask:0xf
    s_nop 1
    v_add_f32_dpp v35, v35, v35 quad_perm:[2,3,0,1] row_mask:0xf bank_mask:0xf
    s_nop 1
    v_add_f32_dpp v35, v35, v35 row_half_mirror row_mask:0xf bank_mask:0xf
    v_mul_f32 v36, 0x3ae38e39, v36
    v_mul_f32 v35, 0x3ae38e39, v35
    v_fma_f32 v35, -v36, v36, v35
    v_max_f32 v35, 0, v35
    s_waitcnt vmcnt(0)
    v_readfirstlane_b32 s8, v24
    v_readfirstlane_b32 s9, v25
    s_nop 0
    s_cmp_lg_u64 s[8:9], 0
    s_cbranch_scc1 L_ab_kernel_tg_10
L_ab_kernel_gt_11:
    buffer_load_dwordx2 v[24:25], off, s[12:15], 0 sc1
    s_waitcnt vmcnt(0)
    v_readfirstlane_b32 s8, v24
    v_readfirstlane_b32 s9, v25
    s_nop 0
    s_cmp_lg_u64 s[8:9], 0
    s_cbranch_scc1 L_ab_kernel_gt_11x
    s_sleep 8
    s_sub_u32 s3, s3, 1
    s_cbranch_scc0 L_ab_kernel_gt_11
L_ab_kernel_gt_11x:
L_ab_kernel_tg_10:
    v_add_f32 v80, 0x3727c5ac, v35
    v_rsq_f32 v80, v80
    v_mov_b32 v82, s8
    v_mov_b32 v83, s9
    v_mul_f32 v81, v80, v36
    v_sub_f32 v81, 0, v81
    s_mov_b32 exec_lo, 0x01010101
    s_mov_b32 exec_hi, 0x01010101
    buffer_store_dwordx4 v[80:83], v32, s[40:43], s55 offen sc1
    s_mov_b64 exec, -1
L_ab_misc:
    v_mov_b32 v28, 0
    v_mov_b32 v29, 0
    v_mov_b32 v30, 0
    v_mov_b32 v31, 0
    s_add_u32 s44, s4, 0x3e5c000
    s_addc_u32 s45, s5, 0
    s_mov_b32 s46, 0x40000
    s_mov_b32 s47, 0x20000
    s_cmp_ge_u32 s2, 64
    s_cbranch_scc1 L_ab_nz
    s_lshl_b32 s17, s2, 2
    s_add_u32 s17, s17, s16
    s_sub_u32 s17, s17, 4
    s_lshl_b32 s17, s17, 10
    buffer_store_dwordx4 v[28:31], v2, s[44:47], s17 offen sc1
L_ab_nz:
    s_cmp_lg_u32 s2, 64
    s_cbranch_scc1 L_ab_nc
    s_add_u32 s44, s4, 0x4361000
    s_addc_u32 s45, s5, 0
    s_mov_b32 s46, 0x1000
    s_mov_b32 s47, 0x20000
    s_sub_u32 s17, s16, 4
    s_lshl_b32 s17, s17, 10
    buffer_store_dwordx4 v[28:31], v2, s[44:47], s17 offen sc1
L_ab_nc:
L_ab_b1:
    s_barrier
L_ab_rp:
    s_cmp_lt_u32 s2, 72
    s_cbranch_scc1 L_ab_x
    v_lshlrev_b32 v26, 4, v0
    v_add_u32 v26, 0, v26
    s_getpc_b64 s[20:21]
L_ab_kernel_pc_12:
    s_add_u32 s20, s20, km_kernel-L_ab_kernel_pc_12
    s_addc_u32 s21, s21, 0
    v_min_u32 v26, L_km_end-km_kernel-12, v26
    global_load_dwordx4 v[28:31], v26, s[20:21]
    v_lshlrev_b32 v26, 4, v0
    v_add_u32 v26, 8192, v26
    s_getpc_b64 s[20:21]
L_ab_kernel_pc_13:
    s_add_u32 s20, s20, km_kernel-L_ab_kernel_pc_13
    s_addc_u32 s21, s21, 0
    v_min_u32 v26, L_km_end-km_kernel-12, v26
    global_load_dwordx4 v[28:31], v26, s[20:21]
    v_lshlrev_b32 v26, 4, v0
    v_add_u32 v26, 16384, v26
    s_getpc_b64 s[20:21]
L_ab_kernel_pc_14:
    s_add_u32 s20, s20, km_kernel-L_ab_kernel_pc_14
    s_addc_u32 s21, s21, 0
    v_min_u32 v26, L_km_end-km_kernel-12, v26
    global_load_dwordx4 v[28:31], v26, s[20:21]
    s_branch L_ab_hfin
L_ab_x:
    s_mov_b32 s36, s30
    s_mov_b32 s37, s31
    s_mov_b32 s38, 0x510000
    s_mov_b32 s39, 0x20000
    s_add_u32 s40, s4, 0xfe8000
    s_addc_u32 s41, s5, 0
    s_mov_b32 s42, 0x534000
    s_mov_b32 s43, 0x20000
    s_add_u32 s44, s4, 0x3ea5000
    s_addc_u32 s45, s5, 0
    s_mov_b32 s46, 0x1b000
    s_mov_b32 s47, 0x20000
    s_mov_b32 s48, s32
    s_mov_b32 s49, s33
    s_mov_b32 s50, 0x2400
    s_mov_b32 s51, 0x20000
    v_lshrrev_b32 v4, 3, v1
    v_mul_u32_u24 v26, 9216, v4
    v_and_b32 v5, 7, v1
    v_lshl_add_u32 v26, v5, 4, v26
    s_mul_i32 s59, s16, 663552
    s_lshl_b32 s17, s2, 7
    s_add_u32 s59, s59, s17
    s_mul_i32 s60, s16, 9216
    s_add_u32 m0, s60, 0
    s_nop 0
    buffer_load_dwordx4 v26, s[36:39], s59 offen  lds
    s_add_u32 s59, s59, 73728
    s_add_u32 m0, s60, 1024
    s_nop 0
    buffer_load_dwordx4 v26, s[36:39], s59 offen  lds
    s_add_u32 s59, s59, 73728
    s_add_u32 m0, s60, 2048
    s_nop 0
    buffer_load_dwordx4 v26, s[36:39], s59 offen  lds
    s_add_u32 s59, s59, 73728
    s_add_u32 m0, s60, 3072
    s_nop 0
    buffer_load_dwordx4 v26, s[36:39], s59 offen  lds
    s_add_u32 s59, s59, 73728
    s_add_u32 m0, s60, 4096
    s_nop 0
    buffer_load_dwordx4 v26, s[36:39], s59 offen  lds
    s_add_u32 s59, s59, 73728
    s_add_u32 m0, s60, 5120
    s_nop 0
    buffer_load_dwordx4 v26, s[36:39], s59 offen  lds
    s_add_u32 s59, s59, 73728
    s_add_u32 m0, s60, 6144
    s_nop 0
    buffer_load_dwordx4 v26, s[36:39], s59 offen  lds
    s_add_u32 s59, s59, 73728
    s_add_u32 m0, s60, 7168
    s_nop 0
    buffer_load_dwordx4 v26, s[36:39], s59 offen  lds
    s_add_u32 s59, s59, 73728
    s_add_u32 m0, s60, 8192
    s_nop 0
    buffer_load_dwordx4 v26, s[36:39], s59 offen  lds
    s_lshr_b32 s57, s16, 1
    s_and_b32 s58, s16, 1
    v_lshrrev_b32 v27, 5, v1
    v_lshlrev_b32 v27, 3, v27
    v_bfe_u32 v5, v1, 2, 2
    v_add_u32 v27, v27, v5
    v_lshlrev_b32 v27, 7, v27
    v_bfe_u32 v4, v1, 4, 1
    v_lshl_add_u32 v27, v4, 5, v27
    v_and_b32 v5, 3, v1
    v_lshl_add_u32 v27, v5, 3, v27
    s_mul_i32 s17, s57, 18432
    s_lshl_b32 s18, s58, 6
    s_add_u32 s17, s17, s18
    v_add_u32 v27, s17, v27
    v_and_b32 v4, 31, v1
    v_lshlrev_b32 v4, 1, v4
    s_lshl_b32 s17, s2, 7
    s_add_u32 s17, s17, s18
    buffer_load_ushort v136, v4, s[48:51], s17 offen
L_ab_kernel_gt_15:
    buffer_load_dwordx2 v[24:25], off, s[12:15], 0 sc1
    s_waitcnt vmcnt(0)
    v_readfirstlane_b32 s8, v24
    v_readfirstlane_b32 s9, v25
    s_nop 0
    s_cmp_lg_u64 s[8:9], 0
    s_cbranch_scc1 L_ab_kernel_gt_15x
    s_sleep 8
    s_sub_u32 s3, s3, 1
    s_cbranch_scc0 L_ab_kernel_gt_15
L_ab_kernel_gt_15x:
    s_barrier
    ds_read_b64_tr_b16 v[32:33], v27 offset:0
    ds_read_b64_tr_b16 v[34:35], v27 offset:512
    ds_read_b64_tr_b16 v[36:37], v27 offset:2048
    ds_read_b64_tr_b16 v[38:39], v27 offset:2560
    ds_read_b64_tr_b16 v[40:41], v27 offset:4096
    ds_read_b64_tr_b16 v[42:43], v27 offset:4608
    ds_read_b64_tr_b16 v[44:45], v27 offset:6144
    ds_read_b64_tr_b16 v[46:47], v27 offset:6656
    ds_read_b64_tr_b16 v[48:49], v27 offset:8192
    ds_read_b64_tr_b16 v[50:51], v27 offset:8704
    ds_read_b64_tr_b16 v[52:53], v27 offset:10240
    ds_read_b64_tr_b16 v[54:55], v27 offset:10752
    ds_read_b64_tr_b16 v[56:57], v27 offset:12288
    ds_read_b64_tr_b16 v[58:59], v27 offset:12800
    ds_read_b64_tr_b16 v[60:61], v27 offset:14336
    ds_read_b64_tr_b16 v[62:63], v27 offset:14848
    ds_read_b64_tr_b16 v[64:65], v27 offset:16384
    ds_read_b64_tr_b16 v[66:67], v27 offset:16896
    s_lshl_b32 s17, s2, 1
    s_add_u32 s17, s17, s58
    s_mul_i32 s59, s17, 37
    s_add_u32 s60, s59, 36
    s_lshl_b32 s60, s60, 10
    s_mul_i32 s18, s57, 9
    s_add_u32 s59, s59, s18
    s_lshl_b32 s59, s59, 10
    s_mul_i32 s17, s57, 2304
    s_add_u32 s54, s17, 27648
    s_add_u32 s55, s17, 36864
L_ab_kernel_msp_16:
    buffer_load_dwordx4 v[68:71], v2, s[44:47], s55 offen offset:0 sc1
    buffer_load_dwordx4 v[72:75], v2, s[44:47], s55 offen offset:1024 sc1
    buffer_load_dwordx4 v[76:79], v2, s[44:47], s55 offen offset:2048 sc1
    buffer_load_dwordx4 v[80:83], v2, s[44:47], s54 offen offset:0 sc1
    buffer_load_dwordx4 v[84:87], v2, s[44:47], s54 offen offset:1024 sc1
    buffer_load_dwordx4 v[88:91], v2, s[44:47], s54 offen offset:2048 sc1
    s_add_u32 s17, s55, 55296
    buffer_load_dwordx4 v[140:143], v2, s[44:47], s17 offen offset:0 sc1
    buffer_load_dwordx4 v[144:147], v2, s[44:47], s17 offen offset:1024 sc1
    buffer_load_dwordx4 v[148:151], v2, s[44:47], s17 offen offset:2048 sc1
    s_add_u32 s17, s54, 55296
    buffer_load_dwordx4 v[152:155], v2, s[44:47], s17 offen offset:0 sc1
    buffer_load_dwordx4 v[156:159], v2, s[44:47], s17 offen offset:1024 sc1
    buffer_load_dwordx4 v[160:163], v2, s[44:47], s17 offen offset:2048 sc1
    s_waitcnt vmcnt(0)
    v_cmp_ne_u64 s[20:21], s[8:9], v[70:71]
    v_cmp_ne_u64 s[22:23], s[8:9], v[74:75]
    s_nop 0
    s_or_b64 s[20:21], s[20:21], s[22:23]
    v_cmp_ne_u64 s[22:23], s[8:9], v[78:79]
    s_nop 0
    s_and_b64 s[22:23], s[22:23], 0xffff
    s_or_b64 s[20:21], s[20:21], s[22:23]
    v_cmp_ne_u64 s[22:23], s[8:9], v[82:83]
    s_nop 0
    s_or_b64 s[20:21], s[20:21], s[22:23]
    v_cmp_ne_u64 s[22:23], s[8:9], v[86:87]
    s_nop 0
    s_or_b64 s[20:21], s[20:21], s[22:23]
    v_cmp_ne_u64 s[22:23], s[8:9], v[90:91]
    s_nop 0
    s_and_b64 s[22:23], s[22:23], 0xffff
    s_or_b64 s[20:21], s[20:21], s[22:23]
    v_cmp_ne_u64 s[22:23], s[8:9], v[142:143]
    s_nop 0
    s_or_b64 s[20:21], s[20:21], s[22:23]
    v_cmp_ne_u64 s[22:23], s[8:9], v[146:147]
    s_nop 0
    s_or_b64 s[20:21], s[20:21], s[22:23]
    v_cmp_ne_u64 s[22:23], s[8:9], v[150:151]
    s_nop 0
    s_and_b64 s[22:23], s[22:23], 0xffff
    s_or_b64 s[20:21], s[20:21], s[22:23]
    v_cmp_ne_u64 s[22:23], s[8:9], v[154:155]
    s_nop 0
    s_or_b64 s[20:21], s[20:21], s[22:23]
    v_cmp_ne_u64 s[22:23], s[8:9], v[158:159]
    s_nop 0
    s_or_b64 s[20:21], s[20:21], s[22:23]
    v_cmp_ne_u64 s[22:23], s[8:9], v[162:163]
    s_nop 0
    s_and_b64 s[22:23], s[22:23], 0xffff
    s_or_b64 s[20:21], s[20:21], s[22:23]
    s_cmp_eq_u64 s[20:21], 0
    s_cbranch_scc1 L_ab_kernel_mok_17
    s_sleep 4
    s_sub_u32 s3, s3, 1
    s_cbranch_scc0 L_ab_kernel_msp_16
L_ab_kernel_mok_17:
    s_mul_i32 s17, s16, 1152
    s_add_u32 s17, s17, 77824
    v_lshl_add_u32 v29, v1, 1, s17
    v_mov_b32 v5, 0x3f80
    v_add_f32 v68, v68, v140
    v_cvt_pk_bf16_f32 v68, v68, v68
    v_and_b32 v68, 0xffff0000, v68
    v_add_f32 v72, v72, v144
    v_cvt_pk_bf16_f32 v72, v72, v72
    v_and_b32 v72, 0xffff0000, v72
    v_add_f32 v76, v76, v148
    v_cvt_pk_bf16_f32 v76, v76, v76
    v_and_b32 v76, 0xffff0000, v76
    v_add_f32 v80, v80, v152
    v_cvt_pk_bf16_f32 v80, v80, v80
    v_and_b32 v80, 0xffff0000, v80
    v_add_f32 v84, v84, v156
    v_cvt_pk_bf16_f32 v84, v84, v84
    v_and_b32 v84, 0xffff0000, v84
    v_add_f32 v88, v88, v160
    v_cvt_pk_bf16_f32 v88, v88, v88
    v_and_b32 v88, 0xffff0000, v88
    v_add_f32 v68, 1.0, v68
    v_cvt_pk_bf16_f32 v68, v68, v68
    ds_write_b16 v29, v68 offset:0
    ds_write_b16_d16_hi v29, v80 offset:384
    ds_write_b16 v29, v5 offset:768
    v_add_f32 v72, 1.0, v72
    v_cvt_pk_bf16_f32 v72, v72, v72
    ds_write_b16 v29, v72 offset:128
    ds_write_b16_d16_hi v29, v84 offset:512
    ds_write_b16 v29, v5 offset:896
    v_add_f32 v76, 1.0, v76
    v_cvt_pk_bf16_f32 v76, v76, v76
    ds_write_b16 v29, v76 offset:256
    ds_write_b16_d16_hi v29, v88 offset:640
    ds_write_b16 v29, v5 offset:1024
    v_and_b32 v4, 31, v1
    v_min_u32 v28, 2, v4
    v_mul_u32_u24 v28, 384, v28
    v_lshrrev_b32 v5, 5, v1
    v_lshl_add_u32 v28, v5, 4, v28
    v_add_u32 v28, s17, v28
    s_waitcnt lgkmcnt(0)
    ds_read_b128 v[68:71], v28 offset:0
    ds_read_b128 v[72:75], v28 offset:32
    ds_read_b128 v[76:79], v28 offset:64
    ds_read_b128 v[80:83], v28 offset:96
    ds_read_b128 v[84:87], v28 offset:128
    ds_read_b128 v[88:91], v28 offset:160
    ds_read_b128 v[92:95], v28 offset:192
    ds_read_b128 v[96:99], v28 offset:224
    ds_read_b128 v[100:103], v28 offset:256
    v_lshlrev_b32 v192, 4, v5
    v_add_u32 v192, s17, v192
    v_mov_b32 v188, 0x3f803f80
    v_mov_b32 v189, 0x3f803f80
    v_mov_b32 v190, 0x3f803f80
    v_mov_b32 v191, 0x3f803f80
    s_waitcnt lgkmcnt(8)
    v_mfma_f32_32x32x16_bf16 v[104:119], v[32:35], v[68:71], 0
    s_waitcnt lgkmcnt(7)
    v_mfma_f32_32x32x16_bf16 v[104:119], v[36:39], v[72:75], v[104:119]
    s_waitcnt lgkmcnt(6)
    v_mfma_f32_32x32x16_bf16 v[104:119], v[40:43], v[76:79], v[104:119]
    s_waitcnt lgkmcnt(5)
    v_mfma_f32_32x32x16_bf16 v[104:119], v[44:47], v[80:83], v[104:119]
    s_waitcnt lgkmcnt(4)
    v_mfma_f32_32x32x16_bf16 v[104:119], v[48:51], v[84:87], v[104:119]
    s_waitcnt lgkmcnt(3)
    v_mfma_f32_32x32x16_bf16 v[104:119], v[52:55], v[88:91], v[104:119]
    s_waitcnt lgkmcnt(2)
    v_mfma_f32_32x32x16_bf16 v[104:119], v[56:59], v[92:95], v[104:119]
    s_waitcnt lgkmcnt(1)
    v_mfma_f32_32x32x16_bf16 v[104:119], v[60:63], v[96:99], v[104:119]
    s_waitcnt lgkmcnt(0)
    v_mfma_f32_32x32x16_bf16 v[104:119], v[64:67], v[100:103], v[104:119]
    v_mfma_f32_32x32x16_bf16 v[120:135], v[68:71], v[68:71], 0
    v_mfma_f32_32x32x16_bf16 v[120:135], v[72:75], v[72:75], v[120:135]
    v_mfma_f32_32x32x16_bf16 v[120:135], v[76:79], v[76:79], v[120:135]
    v_mfma_f32_32x32x16_bf16 v[120:135], v[80:83], v[80:83], v[120:135]
    v_mfma_f32_32x32x16_bf16 v[120:135], v[84:87], v[84:87], v[120:135]
    v_mfma_f32_32x32x16_bf16 v[120:135], v[88:91], v[88:91], v[120:135]
    v_mfma_f32_32x32x16_bf16 v[120:135], v[92:95], v[92:95], v[120:135]
    v_mfma_f32_32x32x16_bf16 v[120:135], v[96:99], v[96:99], v[120:135]
    v_mfma_f32_32x32x16_bf16 v[120:135], v[100:103], v[100:103], v[120:135]
    ds_read_b128 v[140:143], v192 offset:0
    s_waitcnt lgkmcnt(0)
    v_lshlrev_b32 v180, 16, v32
    v_and_b32 v181, 0xffff0000, v32
    v_lshlrev_b32 v182, 16, v140
    v_and_b32 v183, 0xffff0000, v140
    v_mul_f32 v180, v180, v182
    v_mul_f32 v181, v181, v183
    v_cvt_pk_bf16_f32 v32, v180, v181
    v_lshlrev_b32 v180, 16, v33
    v_and_b32 v181, 0xffff0000, v33
    v_lshlrev_b32 v182, 16, v141
    v_and_b32 v183, 0xffff0000, v141
    v_mul_f32 v180, v180, v182
    v_mul_f32 v181, v181, v183
    v_cvt_pk_bf16_f32 v33, v180, v181
    v_lshlrev_b32 v180, 16, v34
    v_and_b32 v181, 0xffff0000, v34
    v_lshlrev_b32 v182, 16, v142
    v_and_b32 v183, 0xffff0000, v142
    v_mul_f32 v180, v180, v182
    v_mul_f32 v181, v181, v183
    v_cvt_pk_bf16_f32 v34, v180, v181
    v_lshlrev_b32 v180, 16, v35
    v_and_b32 v181, 0xffff0000, v35
    v_lshlrev_b32 v182, 16, v143
    v_and_b32 v183, 0xffff0000, v143
    v_mul_f32 v180, v180, v182
    v_mul_f32 v181, v181, v183
    v_cvt_pk_bf16_f32 v35, v180, v181
    buffer_store_dwordx4 v[32:35], v2, s[40:43], s59 offen sc1
    s_add_u32 s59, s59, 1024
    v_mfma_f32_32x32x16_bf16 v[164:179], v[32:35], v[188:191], 0
    ds_read_b128 v[144:147], v192 offset:32
    s_waitcnt lgkmcnt(0)
    v_lshlrev_b32 v180, 16, v36
    v_and_b32 v181, 0xffff0000, v36
    v_lshlrev_b32 v182, 16, v144
    v_and_b32 v183, 0xffff0000, v144
    v_mul_f32 v180, v180, v182
    v_mul_f32 v181, v181, v183
    v_cvt_pk_bf16_f32 v36, v180, v181
    v_lshlrev_b32 v180, 16, v37
    v_and_b32 v181, 0xffff0000, v37
    v_lshlrev_b32 v182, 16, v145
    v_and_b32 v183, 0xffff0000, v145
    v_mul_f32 v180, v180, v182
    v_mul_f32 v181, v181, v183
    v_cvt_pk_bf16_f32 v37, v180, v181
    v_lshlrev_b32 v180, 16, v38
    v_and_b32 v181, 0xffff0000, v38
    v_lshlrev_b32 v182, 16, v146
    v_and_b32 v183, 0xffff0000, v146
    v_mul_f32 v180, v180, v182
    v_mul_f32 v181, v181, v183
    v_cvt_pk_bf16_f32 v38, v180, v181
    v_lshlrev_b32 v180, 16, v39
    v_and_b32 v181, 0xffff0000, v39
    v_lshlrev_b32 v182, 16, v147
    v_and_b32 v183, 0xffff0000, v147
    v_mul_f32 v180, v180, v182
    v_mul_f32 v181, v181, v183
    v_cvt_pk_bf16_f32 v39, v180, v181
    buffer_store_dwordx4 v[36:39], v2, s[40:43], s59 offen sc1
    s_add_u32 s59, s59, 1024
    v_mfma_f32_32x32x16_bf16 v[164:179], v[36:39], v[188:191], v[164:179]
    ds_read_b128 v[140:143], v192 offset:64
    s_waitcnt lgkmcnt(0)
    v_lshlrev_b32 v180, 16, v40
    v_and_b32 v181, 0xffff0000, v40
    v_lshlrev_b32 v182, 16, v140
    v_and_b32 v183, 0xffff0000, v140
    v_mul_f32 v180, v180, v182
    v_mul_f32 v181, v181, v183
    v_cvt_pk_bf16_f32 v40, v180, v181
    v_lshlrev_b32 v180, 16, v41
    v_and_b32 v181, 0xffff0000, v41
    v_lshlrev_b32 v182, 16, v141
    v_and_b32 v183, 0xffff0000, v141
    v_mul_f32 v180, v180, v182
    v_mul_f32 v181, v181, v183
    v_cvt_pk_bf16_f32 v41, v180, v181
    v_lshlrev_b32 v180, 16, v42
    v_and_b32 v181, 0xffff0000, v42
    v_lshlrev_b32 v182, 16, v142
    v_and_b32 v183, 0xffff0000, v142
    v_mul_f32 v180, v180, v182
    v_mul_f32 v181, v181, v183
    v_cvt_pk_bf16_f32 v42, v180, v181
    v_lshlrev_b32 v180, 16, v43
    v_and_b32 v181, 0xffff0000, v43
    v_lshlrev_b32 v182, 16, v143
    v_and_b32 v183, 0xffff0000, v143
    v_mul_f32 v180, v180, v182
    v_mul_f32 v181, v181, v183
    v_cvt_pk_bf16_f32 v43, v180, v181
    buffer_store_dwordx4 v[40:43], v2, s[40:43], s59 offen sc1
    s_add_u32 s59, s59, 1024
    v_mfma_f32_32x32x16_bf16 v[164:179], v[40:43], v[188:191], v[164:179]
    ds_read_b128 v[144:147], v192 offset:96
    s_waitcnt lgkmcnt(0)
    v_lshlrev_b32 v180, 16, v44
    v_and_b32 v181, 0xffff0000, v44
    v_lshlrev_b32 v182, 16, v144
    v_and_b32 v183, 0xffff0000, v144
    v_mul_f32 v180, v180, v182
    v_mul_f32 v181, v181, v183
    v_cvt_pk_bf16_f32 v44, v180, v181
    v_lshlrev_b32 v180, 16, v45
    v_and_b32 v181, 0xffff0000, v45
    v_lshlrev_b32 v182, 16, v145
    v_and_b32 v183, 0xffff0000, v145
    v_mul_f32 v180, v180, v182
    v_mul_f32 v181, v181, v183
    v_cvt_pk_bf16_f32 v45, v180, v181
    v_lshlrev_b32 v180, 16, v46
    v_and_b32 v181, 0xffff0000, v46
    v_lshlrev_b32 v182, 16, v146
    v_and_b32 v183, 0xffff0000, v146
    v_mul_f32 v180, v180, v182
    v_mul_f32 v181, v181, v183
    v_cvt_pk_bf16_f32 v46, v180, v181
    v_lshlrev_b32 v180, 16, v47
    v_and_b32 v181, 0xffff0000, v47
    v_lshlrev_b32 v182, 16, v147
    v_and_b32 v183, 0xffff0000, v147
    v_mul_f32 v180, v180, v182
    v_mul_f32 v181, v181, v183
    v_cvt_pk_bf16_f32 v47, v180, v181
    buffer_store_dwordx4 v[44:47], v2, s[40:43], s59 offen sc1
    s_add_u32 s59, s59, 1024
    v_mfma_f32_32x32x16_bf16 v[164:179], v[44:47], v[188:191], v[164:179]
    ds_read_b128 v[140:143], v192 offset:128
    s_waitcnt lgkmcnt(0)
    v_lshlrev_b32 v180, 16, v48
    v_and_b32 v181, 0xffff0000, v48
    v_lshlrev_b32 v182, 16, v140
    v_and_b32 v183, 0xffff0000, v140
    v_mul_f32 v180, v180, v182
    v_mul_f32 v181, v181, v183
    v_cvt_pk_bf16_f32 v48, v180, v181
    v_lshlrev_b32 v180, 16, v49
    v_and_b32 v181, 0xffff0000, v49
    v_lshlrev_b32 v182, 16, v141
    v_and_b32 v183, 0xffff0000, v141
    v_mul_f32 v180, v180, v182
    v_mul_f32 v181, v181, v183
    v_cvt_pk_bf16_f32 v49, v180, v181
    v_lshlrev_b32 v180, 16, v50
    v_and_b32 v181, 0xffff0000, v50
    v_lshlrev_b32 v182, 16, v142
    v_and_b32 v183, 0xffff0000, v142
    v_mul_f32 v180, v180, v182
    v_mul_f32 v181, v181, v183
    v_cvt_pk_bf16_f32 v50, v180, v181
    v_lshlrev_b32 v180, 16, v51
    v_and_b32 v181, 0xffff0000, v51
    v_lshlrev_b32 v182, 16, v143
    v_and_b32 v183, 0xffff0000, v143
    v_mul_f32 v180, v180, v182
    v_mul_f32 v181, v181, v183
    v_cvt_pk_bf16_f32 v51, v180, v181
    buffer_store_dwordx4 v[48:51], v2, s[40:43], s59 offen sc1
    s_add_u32 s59, s59, 1024
    v_mfma_f32_32x32x16_bf16 v[164:179], v[48:51], v[188:191], v[164:179]
    ds_read_b128 v[144:147], v192 offset:160
    s_waitcnt lgkmcnt(0)
    v_lshlrev_b32 v180, 16, v52
    v_and_b32 v181, 0xffff0000, v52
    v_lshlrev_b32 v182, 16, v144
    v_and_b32 v183, 0xffff0000, v144
    v_mul_f32 v180, v180, v182
    v_mul_f32 v181, v181, v183
    v_cvt_pk_bf16_f32 v52, v180, v181
    v_lshlrev_b32 v180, 16, v53
    v_and_b32 v181, 0xffff0000, v53
    v_lshlrev_b32 v182, 16, v145
    v_and_b32 v183, 0xffff0000, v145
    v_mul_f32 v180, v180, v182
    v_mul_f32 v181, v181, v183
    v_cvt_pk_bf16_f32 v53, v180, v181
    v_lshlrev_b32 v180, 16, v54
    v_and_b32 v181, 0xffff0000, v54
    v_lshlrev_b32 v182, 16, v146
    v_and_b32 v183, 0xffff0000, v146
    v_mul_f32 v180, v180, v182
    v_mul_f32 v181, v181, v183
    v_cvt_pk_bf16_f32 v54, v180, v181
    v_lshlrev_b32 v180, 16, v55
    v_and_b32 v181, 0xffff0000, v55
    v_lshlrev_b32 v182, 16, v147
    v_and_b32 v183, 0xffff0000, v147
    v_mul_f32 v180, v180, v182
    v_mul_f32 v181, v181, v183
    v_cvt_pk_bf16_f32 v55, v180, v181
    buffer_store_dwordx4 v[52:55], v2, s[40:43], s59 offen sc1
    s_add_u32 s59, s59, 1024
    v_mfma_f32_32x32x16_bf16 v[164:179], v[52:55], v[188:191], v[164:179]
    ds_read_b128 v[140:143], v192 offset:192
    s_waitcnt lgkmcnt(0)
    v_lshlrev_b32 v180, 16, v56
    v_and_b32 v181, 0xffff0000, v56
    v_lshlrev_b32 v182, 16, v140
    v_and_b32 v183, 0xffff0000, v140
    v_mul_f32 v180, v180, v182
    v_mul_f32 v181, v181, v183
    v_cvt_pk_bf16_f32 v56, v180, v181
    v_lshlrev_b32 v180, 16, v57
    v_and_b32 v181, 0xffff0000, v57
    v_lshlrev_b32 v182, 16, v141
    v_and_b32 v183, 0xffff0000, v141
    v_mul_f32 v180, v180, v182
    v_mul_f32 v181, v181, v183
    v_cvt_pk_bf16_f32 v57, v180, v181
    v_lshlrev_b32 v180, 16, v58
    v_and_b32 v181, 0xffff0000, v58
    v_lshlrev_b32 v182, 16, v142
    v_and_b32 v183, 0xffff0000, v142
    v_mul_f32 v180, v180, v182
    v_mul_f32 v181, v181, v183
    v_cvt_pk_bf16_f32 v58, v180, v181
    v_lshlrev_b32 v180, 16, v59
    v_and_b32 v181, 0xffff0000, v59
    v_lshlrev_b32 v182, 16, v143
    v_and_b32 v183, 0xffff0000, v143
    v_mul_f32 v180, v180, v182
    v_mul_f32 v181, v181, v183
    v_cvt_pk_bf16_f32 v59, v180, v181
    buffer_store_dwordx4 v[56:59], v2, s[40:43], s59 offen sc1
    s_add_u32 s59, s59, 1024
    v_mfma_f32_32x32x16_bf16 v[164:179], v[56:59], v[188:191], v[164:179]
    ds_read_b128 v[144:147], v192 offset:224
    s_waitcnt lgkmcnt(0)
    v_lshlrev_b32 v180, 16, v60
    v_and_b32 v181, 0xffff0000, v60
    v_lshlrev_b32 v182, 16, v144
    v_and_b32 v183, 0xffff0000, v144
    v_mul_f32 v180, v180, v182
    v_mul_f32 v181, v181, v183
    v_cvt_pk_bf16_f32 v60, v180, v181
    v_lshlrev_b32 v180, 16, v61
    v_and_b32 v181, 0xffff0000, v61
    v_lshlrev_b32 v182, 16, v145
    v_and_b32 v183, 0xffff0000, v145
    v_mul_f32 v180, v180, v182
    v_mul_f32 v181, v181, v183
    v_cvt_pk_bf16_f32 v61, v180, v181
    v_lshlrev_b32 v180, 16, v62
    v_and_b32 v181, 0xffff0000, v62
    v_lshlrev_b32 v182, 16, v146
    v_and_b32 v183, 0xffff0000, v146
    v_mul_f32 v180, v180, v182
    v_mul_f32 v181, v181, v183
    v_cvt_pk_bf16_f32 v62, v180, v181
    v_lshlrev_b32 v180, 16, v63
    v_and_b32 v181, 0xffff0000, v63
    v_lshlrev_b32 v182, 16, v147
    v_and_b32 v183, 0xffff0000, v147
    v_mul_f32 v180, v180, v182
    v_mul_f32 v181, v181, v183
    v_cvt_pk_bf16_f32 v63, v180, v181
    buffer_store_dwordx4 v[60:63], v2, s[40:43], s59 offen sc1
    s_add_u32 s59, s59, 1024
    v_mfma_f32_32x32x16_bf16 v[164:179], v[60:63], v[188:191], v[164:179]
    ds_read_b128 v[140:143], v192 offset:256
    s_waitcnt lgkmcnt(0)
    v_lshlrev_b32 v180, 16, v64
    v_and_b32 v181, 0xffff0000, v64
    v_lshlrev_b32 v182, 16, v140
    v_and_b32 v183, 0xffff0000, v140
    v_mul_f32 v180, v180, v182
    v_mul_f32 v181, v181, v183
    v_cvt_pk_bf16_f32 v64, v180, v181
    v_lshlrev_b32 v180, 16, v65
    v_and_b32 v181, 0xffff0000, v65
    v_lshlrev_b32 v182, 16, v141
    v_and_b32 v183, 0xffff0000, v141
    v_mul_f32 v180, v180, v182
    v_mul_f32 v181, v181, v183
    v_cvt_pk_bf16_f32 v65, v180, v181
    v_lshlrev_b32 v180, 16, v66
    v_and_b32 v181, 0xffff0000, v66
    v_lshlrev_b32 v182, 16, v142
    v_and_b32 v183, 0xffff0000, v142
    v_mul_f32 v180, v180, v182
    v_mul_f32 v181, v181, v183
    v_cvt_pk_bf16_f32 v66, v180, v181
    v_lshlrev_b32 v180, 16, v67
    v_and_b32 v181, 0xffff0000, v67
    v_lshlrev_b32 v182, 16, v143
    v_and_b32 v183, 0xffff0000, v143
    v_mul_f32 v180, v180, v182
    v_mul_f32 v181, v181, v183
    v_cvt_pk_bf16_f32 v67, v180, v181
    buffer_store_dwordx4 v[64:67], v2, s[40:43], s59 offen sc1
    s_nop 0
    v_mfma_f32_32x32x16_bf16 v[164:179], v[64:67], v[188:191], v[164:179]
    v_cmp_eq_u32 vcc, 0, v4
    s_nop 10
    v_cndmask_b32 v104, v104, v164, vcc
    v_cndmask_b32 v105, v105, v165, vcc
    v_cndmask_b32 v106, v106, v166, vcc
    v_cndmask_b32 v107, v107, v167, vcc
    v_cndmask_b32 v108, v108, v168, vcc
    v_cndmask_b32 v109, v109, v169, vcc
    v_cndmask_b32 v110, v110, v170, vcc
    v_cndmask_b32 v111, v111, v171, vcc
    v_cndmask_b32 v112, v112, v172, vcc
    v_cndmask_b32 v113, v113, v173, vcc
    v_cndmask_b32 v114, v114, v174, vcc
    v_cndmask_b32 v115, v115, v175, vcc
    v_cndmask_b32 v116, v116, v176, vcc
    v_cndmask_b32 v117, v117, v177, vcc
    v_cndmask_b32 v118, v118, v178, vcc
    v_cndmask_b32 v119, v119, v179, vcc
    s_lshl_b32 s17, s58, 2
    s_add_u32 s17, s17, s57
    s_mul_i32 s17, s17, 384
    s_add_u32 s17, s17, 90112
    v_lshlrev_b32 v29, 7, v4
    v_lshl_add_u32 v29, v5, 4, v29
    v_add_u32 v29, s17, v29
    s_mul_i32 s17, s58, 1536
    s_add_u32 s17, s17, 90112
    v_lshl_add_u32 v30, v4, 2, s17
    s_mov_b32 exec_lo, 7
    s_mov_b32 exec_hi, 7
    ds_write_b128 v29, v[104:107] offset:0
    ds_write_b128 v29, v[108:111] offset:32
    ds_write_b128 v29, v[112:115] offset:64
    ds_write_b128 v29, v[116:119] offset:96
    s_lshl_b32 s17, s16, 6
    s_add_u32 s17, s17, 94208
    v_add_u32 v29, s17, v2
    s_mov_b64 exec, 7
    ds_write_b128 v29, v[120:123]
    s_mov_b64 exec, -1
    s_waitcnt lgkmcnt(0)
    s_barrier
    s_cmp_lg_u32 s2, 0
    s_cbranch_scc1 L_ab_ng
    s_cmp_lg_u32 s16, 2
    s_cbranch_scc1 L_ab_ng
    v_add_u32 v29, 94208, v2
    s_mov_b64 exec, 7
    ds_read_b128 v[120:123], v29 offset:0
    ds_read_b128 v[124:127], v29 offset:128
    ds_read_b128 v[128:131], v29 offset:256
    ds_read_b128 v[132:135], v29 offset:384
    s_add_u32 s44, s4, 0x3ec0000
    s_addc_u32 s45, s5, 0
    s_mov_b32 s46, 0xd80
    s_mov_b32 s47, 0x20000
    s_waitcnt lgkmcnt(0)
    v_add_f32 v120, v120, v124
    v_add_f32 v121, v121, v125
    v_add_f32 v122, v122, v126
    v_add_f32 v123, v123, v127
    v_add_f32 v120, v120, v128
    v_add_f32 v121, v121, v129
    v_add_f32 v122, v122, v130
    v_add_f32 v123, v123, v131
    v_add_f32 v120, v120, v132
    v_add_f32 v121, v121, v133
    v_add_f32 v122, v122, v134
    v_add_f32 v123, v123, v135
    buffer_store_dwordx4 v[120:123], v2, s[44:47], 0 offen sc1
    s_mov_b64 exec, -1
L_ab_ng:
    s_cmp_lg_u32 s57, 0
    s_cbranch_scc1 L_ab_hfin
    ds_read_b32 v120, v30 offset:0
    ds_read_b32 v121, v30 offset:384
    ds_read_b32 v122, v30 offset:768
    ds_read_b32 v123, v30 offset:1152
    ds_read_b32 v124, v30 offset:128
    ds_read_b32 v125, v30 offset:512
    ds_read_b32 v126, v30 offset:896
    ds_read_b32 v127, v30 offset:1280
    ds_read_b32 v128, v30 offset:256
    ds_read_b32 v129, v30 offset:640
    ds_read_b32 v130, v30 offset:1024
    ds_read_b32 v131, v30 offset:1408
    s_waitcnt lgkmcnt(0)
    v_add_f32 v120, v120, v121
    v_add_f32 v122, v122, v123
    v_add_f32 v120, v120, v122
    v_cvt_pk_bf16_f32 v104, v120, v120
    v_and_b32 v104, 0xffff0000, v104
    v_sub_f32 v108, v120, v104
    v_add_f32 v124, v124, v125
    v_add_f32 v126, v126, v127
    v_add_f32 v124, v124, v126
    v_cvt_pk_bf16_f32 v105, v124, v124
    v_and_b32 v105, 0xffff0000, v105
    v_sub_f32 v109, v124, v105
    v_add_f32 v128, v128, v129
    v_add_f32 v130, v130, v131
    v_add_f32 v128, v128, v130
    v_cvt_pk_bf16_f32 v106, v128, v128
    v_and_b32 v106, 0xffff0000, v106
    v_sub_f32 v110, v128, v106
    v_lshlrev_b32 v136, 16, v136
    v_cvt_pk_bf16_f32 v112, v104, v108
    v_cvt_pk_bf16_f32 v113, v104, v105
    v_cvt_pk_bf16_f32 v114, v109, v105
    v_cvt_pk_bf16_f32 v115, v106, v110
    v_cvt_pk_bf16_f32 v116, v106, v136
    v_cvt_pk_bf16_f32 v117, v136, v136
    v_cmp_gt_u32 vcc, 32, v1
    s_nop 1
    v_cndmask_b32 v112, v116, v112, vcc
    v_cndmask_b32 v113, v117, v113, vcc
    v_cndmask_b32 v114, 0, v114, vcc
    v_cndmask_b32 v115, 0, v115, vcc
    buffer_store_dwordx4 v[112:115], v2, s[40:43], s60 offen sc1
    s_branch L_ab_hfin
L_ab_hfin:
    s_endpgm
L_ab_end:
    s_endpgm
.text
.globl km_kernel
.p2align 8
.type km_kernel,@function
km_kernel:
    s_cmp_ge_u32 s2, 256
    s_cbranch_scc1 L_km_end
    s_load_dwordx2 s[4:5], s[0:1], 144
    s_load_dwordx2 s[6:7], s[0:1], 104
    s_load_dwordx2 s[8:9], s[0:1], 128
    s_mov_b32 s3, 0x40000
    s_getreg_b32 s59, hwreg(HW_REG_XCC_ID)
    s_and_b32 s59, s59, 7
    s_lshr_b32 s60, s2, 6
    s_lshl_b32 s60, s60, 3
    s_add_u32 s59, s59, s60
    v_mov_b32 v213, 159744
    v_cmp_eq_u32 vcc, 0, v0
    s_nop 0
    s_and_saveexec_b64 s[76:77], vcc
    s_cbranch_execz L_km_cw
    s_waitcnt lgkmcnt(0)
    s_add_u32 s44, s4, 0x4361000
    s_addc_u32 s45, s5, 0
    s_mov_b32 s46, 0x1000
    s_mov_b32 s47, 0x20000
L_km_cl:
    s_lshl_b32 s60, s59, 7
    v_mov_b32 v212, 1
    buffer_atomic_add v212, off, s[44:47], s60 sc0 sc1
    s_waitcnt vmcnt(0)
    v_readfirstlane_b32 s60, v212
    s_nop 0
    s_cmp_lt_u32 s60, 8
    s_cbranch_scc1 L_km_cg
    s_add_u32 s59, s59, 1
    s_and_b32 s59, s59, 31
    s_sub_u32 s3, s3, 1
    s_cbranch_scc0 L_km_cl
    s_and_b32 s60, s60, 7
L_km_cg:
    s_lshl_b32 s60, s60, 3
    s_and_b32 s52, s59, 7
    s_add_u32 s60, s60, s52
    s_lshr_b32 s59, s59, 3
    s_lshl_b32 s59, s59, 6
    s_add_u32 s60, s60, s59
    v_mov_b32 v212, s60
    ds_write_b32 v213, v212
    s_waitcnt lgkmcnt(0)
L_km_cw:
    s_mov_b64 exec, -1
    s_barrier
    ds_read_b32 v212, v213
    s_waitcnt lgkmcnt(0)
    v_readfirstlane_b32 s2, v212
    v_lshrrev_b32 v212, 6, v0
    v_and_b32 v213, 63, v0
    v_readfirstlane_b32 s52, v212
    v_lshlrev_b32 v1, 4, v213
    s_lshr_b32 s59, s2, 2
    s_and_b32 s59, s59, 1
    s_lshl_b32 s59, s59, 3
    s_lshr_b32 s53, s2, 5
    s_add_u32 s53, s53, s59
    s_and_b32 s54, s2, 3
    s_lshr_b32 s55, s2, 3
    s_and_b32 s55, s55, 3
    s_lshl_b32 s58, s54, 2
    s_add_u32 s58, s58, s55
    s_mul_i32 s66, s58, 336
    s_mul_i32 s58, s58, 9
    s_and_b32 s56, s52, 3
    s_lshr_b32 s57, s52, 2
    s_lshl_b32 s59, s52, 14
    s_lshl_b32 s60, s53, 10
    s_add_u32 s61, s59, s60
    s_add_u32 s62, s61, 131072
    s_add_u32 s59, s58, s57
    s_mul_i32 s59, s59, 37
    s_add_u32 s63, s59, s56
    s_lshl_b32 s63, s63, 10
    s_mul_i32 s60, s56, 3
    s_add_u32 s64, s59, s60
    s_lshl_b32 s64, s64, 10
    s_mul_i32 s60, s52, 3
    s_add_u32 s59, s58, 8
    s_mul_i32 s59, s59, 37
    s_add_u32 s65, s59, s60
    s_lshl_b32 s65, s65, 10
    s_add_u32 s66, s66, s60
    s_lshl_b32 s66, s66, 10
    s_lshl_b32 s67, s52, 10
    s_lshl_b32 s68, s60, 10
    s_waitcnt lgkmcnt(0)
    s_add_u32 s24, s4, 0x3ec1000
    s_addc_u32 s25, s5, 0
    s_mov_b32 s26, 0x240000
    s_mov_b32 s27, 0x20000
    s_add_u32 s28, s4, 0xfe8000
    s_addc_u32 s29, s5, 0
    s_mov_b32 s30, 0x534000
    s_mov_b32 s31, 0x20000
    s_add_u32 m0, s67, 0
    s_add_u32 s69, s61, 0
    buffer_load_dwordx4 v1, s[24:27], s69 offen  lds
    s_add_u32 m0, s67, 8192
    s_add_u32 s69, s62, 0
    buffer_load_dwordx4 v1, s[24:27], s69 offen  lds
    s_add_u32 m0, s67, 16384
    s_add_u32 s69, s63, 0
    buffer_load_dwordx4 v1, s[28:31], s69 offen  lds
    s_add_u32 m0, s67, 24576
    s_add_u32 s69, s61, 262144
    buffer_load_dwordx4 v1, s[24:27], s69 offen  lds
    s_add_u32 m0, s67, 32768
    s_add_u32 s69, s62, 262144
    buffer_load_dwordx4 v1, s[24:27], s69 offen  lds
    s_add_u32 m0, s67, 40960
    s_add_u32 s69, s63, 4096
    buffer_load_dwordx4 v1, s[28:31], s69 offen  lds
    s_add_u32 s40, s4, 0x3ec1000
    s_addc_u32 s41, s5, 0
    s_mov_b32 s42, 0x240000
    s_mov_b32 s43, 0x20000
    s_mov_b32 s48, s4
    s_mov_b32 s49, s5
    s_mov_b32 s50, 0x3600
    s_mov_b32 s51, 0x20000
    v_lshrrev_b32 v212, 3, v0
    v_lshlrev_b32 v228, 14, v212
    v_and_b32 v214, 7, v0
    v_lshl_add_u32 v228, v214, 3, v228
    v_lshlrev_b32 v229, 4, v212
    s_lshl_b32 s59, s54, 2
    s_add_u32 s59, s59, s55
    s_lshl_b32 s59, s59, 3
    s_lshl_b32 s60, s53, 7
    s_add_u32 s75, s59, s60
    s_lshl_b32 s59, s75, 3
    s_movk_i32 s60, 6912
    s_movk_i32 s71, 9216
    buffer_load_dwordx2 v[176:177], v228, s[40:43], s59 offen
    buffer_load_dwordx4 v[216:219], v229, s[48:51], s71 offen offset:0
    buffer_load_dwordx4 v[236:239], v229, s[48:51], s60 offen offset:0
    s_add_u32 s59, s59, 1048576
    buffer_load_dwordx2 v[178:179], v228, s[40:43], s59 offen
    buffer_load_dwordx4 v[220:223], v229, s[48:51], s71 offen offset:1024
    buffer_load_dwordx4 v[240:243], v229, s[48:51], s60 offen offset:1024
    s_add_u32 s59, s59, 1048576
    s_cmp_ge_u32 s52, 2
    s_cbranch_scc1 L_km_s2
    buffer_load_dwordx2 v[180:181], v228, s[40:43], s59 offen
    buffer_load_dwordx4 v[224:227], v229, s[48:51], s71 offen offset:2048
    buffer_load_dwordx4 v[244:247], v229, s[48:51], s60 offen offset:2048
L_km_s2:
    s_add_u32 m0, s67, 49152
    s_add_u32 s69, s61, 524288
    buffer_load_dwordx4 v1, s[24:27], s69 offen  lds
    s_add_u32 m0, s67, 57344
    s_add_u32 s69, s62, 524288
    buffer_load_dwordx4 v1, s[24:27], s69 offen  lds
    s_add_u32 m0, s67, 65536
    s_add_u32 s69, s63, 8192
    buffer_load_dwordx4 v1, s[28:31], s69 offen  lds
    s_add_u32 m0, s67, 73728
    s_add_u32 s69, s61, 786432
    buffer_load_dwordx4 v1, s[24:27], s69 offen  lds
    s_add_u32 m0, s67, 81920
    s_add_u32 s69, s62, 786432
    buffer_load_dwordx4 v1, s[24:27], s69 offen  lds
    s_add_u32 m0, s67, 90112
    s_add_u32 s69, s63, 12288
    buffer_load_dwordx4 v1, s[28:31], s69 offen  lds
    s_add_u32 m0, s67, 98304
    s_add_u32 s69, s61, 1048576
    buffer_load_dwordx4 v1, s[24:27], s69 offen  lds
    s_add_u32 m0, s67, 106496
    s_add_u32 s69, s62, 1048576
    buffer_load_dwordx4 v1, s[24:27], s69 offen  lds
    s_add_u32 m0, s67, 114688
    s_add_u32 s69, s63, 16384
    buffer_load_dwordx4 v1, s[28:31], s69 offen  lds
    s_add_u32 s59, s58, s52
    s_mul_i32 s59, s59, 37
    s_add_u32 s59, s59, 36
    s_lshl_b32 s59, s59, 10
    s_add_u32 m0, s67, 147456
    s_nop 0
    buffer_load_dwordx4 v1, s[28:31], s59 offen lds
    s_cmp_lg_u32 s52, 0
    s_cbranch_scc1 L_km_a8
    s_add_u32 s59, s59, 303104
    s_mov_b32 m0, 155648
    s_nop 0
    buffer_load_dwordx4 v1, s[28:31], s59 offen lds
L_km_a8:
    s_add_u32 s78, s4, 0x3ec0000
    s_addc_u32 s79, s5, 0
    s_load_dwordx8 s[12:19], s[78:79], 0
    s_load_dwordx2 s[20:21], s[78:79], 32
    s_add_u32 s76, s4, 0x3e9c000
    s_addc_u32 s77, s5, 0
    s_load_dwordx2 s[10:11], s[76:77], 0
    s_add_u32 s32, s4, 0x151c000
    s_addc_u32 s33, s5, 0
    s_mov_b32 s34, 0x540000
    s_mov_b32 s35, 0x20000
    s_add_u32 s36, s4, 0x1a5c000
    s_addc_u32 s37, s5, 0
    s_mov_b32 s38, 0x1200000
    s_mov_b32 s39, 0x20000
    s_add_u32 s44, s4, 0x3e5c000
    s_addc_u32 s45, s5, 0
    s_mov_b32 s46, 0x40000
    s_mov_b32 s47, 0x20000
    s_add_u32 s40, s4, 0x4341000
    s_addc_u32 s41, s5, 0
    s_mov_b32 s42, 0x20000
    s_mov_b32 s43, 0x20000
    v_lshrrev_b32 v212, 5, v213
    v_lshlrev_b32 v9, 11, v212
    v_and_b32 v212, 31, v213
    v_lshl_add_u32 v9, v212, 3, v9
    s_lshl_b32 s60, s56, 8
    v_add_u32 v9, s60, v9
    s_lshl_b32 s60, s57, 12
    s_add_u32 s60, s60, 16384
    v_add_u32 v6, s60, v1
    s_mul_i32 s60, s57, 12288
    v_add_u32 v12, s60, v1
    v_add_u32 v10, 49152, v9
    v_add_u32 v11, 98304, v9
    v_add_u32 v7, 49152, v6
    v_add_u32 v8, 98304, v6
    v_add_u32 v13, 49152, v12
    v_add_u32 v14, 98304, v12
    s_lshl_b32 s60, s57, 10
    s_add_u32 s60, s60, 147456
    v_add_u32 v15, s60, v1
    s_lshl_b32 s59, s53, 2
    s_add_u32 s59, s59, s56
    s_mul_i32 s59, s59, 144
    s_add_u32 s70, s59, s58
    s_add_u32 s70, s70, s57
    s_lshl_b32 s70, s70, 11
    s_mul_i32 s60, s54, 36
    s_add_u32 s59, s59, s60
    s_add_u32 s72, s59, s57
    s_lshl_b32 s72, s72, 11
    s_mul_i32 s60, s57, 9
    s_add_u32 s73, s59, s60
    s_add_u32 s73, s73, 8
    s_lshl_b32 s73, s73, 11
    s_lshl_b32 s74, s2, 10
    s_lshl_b32 s60, s52, 7
    s_add_u32 s74, s74, s60
    s_and_b32 s59, s2, 0xffffffe7
    s_lshl_b32 s59, s59, 10
    s_add_u32 s59, s59, s60
    v_and_b32 v212, 3, v213
    v_lshlrev_b32 v4, 13, v212
    v_add_u32 v4, s59, v4
    s_and_b32 s59, s55, 1
    s_cmp_eq_u32 s59, s57
    s_cselect_b64 vcc, -1, 0
    s_waitcnt vmcnt(19)
    s_waitcnt lgkmcnt(0)
    s_barrier
    ds_read_b128 v[192:195], v6 offset:0
    ds_read_b64 v[16:17], v9 offset:0
    ds_read_b64 v[18:19], v9 offset:1024
    ds_read_b128 v[196:199], v6 offset:1024
    ds_read_b64 v[20:21], v9 offset:4096
    ds_read_b64 v[22:23], v9 offset:5120
    ds_read_b128 v[200:203], v6 offset:2048
    ds_read_b64 v[24:25], v9 offset:8192
    ds_read_b64 v[26:27], v9 offset:9216
    ds_read_b128 v[204:207], v6 offset:3072
    ds_read_b64 v[28:29], v9 offset:12288
    ds_read_b64 v[30:31], v9 offset:13312
    s_add_u32 m0, s67, 122880
    s_add_u32 s69, s61, 1310720
    buffer_load_dwordx4 v1, s[24:27], s69 offen  lds
    s_add_u32 m0, s67, 131072
    s_add_u32 s69, s62, 1310720
    buffer_load_dwordx4 v1, s[24:27], s69 offen  lds
    s_add_u32 m0, s67, 139264
    s_add_u32 s69, s63, 20480
    buffer_load_dwordx4 v1, s[28:31], s69 offen  lds
    s_setprio 1
    s_waitcnt lgkmcnt(6)
    v_mfma_f32_32x32x16_bf16 v[160:175], v[192:195], v[16:19], 0
    v_mfma_f32_32x32x16_bf16 v[160:175], v[196:199], v[20:23], v[160:175]
    s_waitcnt lgkmcnt(0)
    v_mfma_f32_32x32x16_bf16 v[160:175], v[200:203], v[24:27], v[160:175]
    v_mfma_f32_32x32x16_bf16 v[160:175], v[204:207], v[28:31], v[160:175]
    s_setprio 0
    s_waitcnt vmcnt(13)
    v_lshlrev_b32 v228, 16, v176
    v_and_b32 v229, 0xffff0000, v176
    v_lshlrev_b32 v230, 16, v177
    v_and_b32 v231, 0xffff0000, v177
    v_mul_f32 v232, v228, v216
    v_mul_f32 v233, v229, v217
    v_mul_f32 v234, v230, v218
    v_mul_f32 v235, v231, v219
    v_mov_b32 v184, v228
    v_mul_f32 v185, v228, v228
    v_mov_b32 v186, v232
    v_mul_f32 v187, v232, v232
    v_mul_f32 v188, v232, v216
    v_mul_f32 v189, v232, v236
    v_add_f32 v184, v184, v229
    v_fmac_f32 v185, v229, v229
    v_add_f32 v186, v186, v233
    v_fmac_f32 v187, v233, v233
    v_fmac_f32 v188, v233, v217
    v_fmac_f32 v189, v233, v237
    v_add_f32 v184, v184, v230
    v_fmac_f32 v185, v230, v230
    v_add_f32 v186, v186, v234
    v_fmac_f32 v187, v234, v234
    v_fmac_f32 v188, v234, v218
    v_fmac_f32 v189, v234, v238
    v_add_f32 v184, v184, v231
    v_fmac_f32 v185, v231, v231
    v_add_f32 v186, v186, v235
    v_fmac_f32 v187, v235, v235
    v_fmac_f32 v188, v235, v219
    v_fmac_f32 v189, v235, v239
    s_barrier
    s_add_u32 m0, s67, 0
    s_add_u32 s69, s61, 1572864
    buffer_load_dwordx4 v1, s[24:27], s69 offen  lds
    s_add_u32 m0, s67, 8192
    s_add_u32 s69, s62, 1572864
    buffer_load_dwordx4 v1, s[24:27], s69 offen  lds
    s_add_u32 m0, s67, 16384
    s_add_u32 s69, s63, 24576
    buffer_load_dwordx4 v1, s[28:31], s69 offen  lds
    s_setprio 1
    ds_read_b128 v[192:195], v6 offset:24576
    ds_read_b64 v[32:33], v9 offset:24576
    ds_read_b64 v[34:35], v9 offset:25600
    ds_read_b128 v[196:199], v6 offset:25600
    ds_read_b64 v[36:37], v9 offset:28672
    ds_read_b64 v[38:39], v9 offset:29696
    ds_read_b128 v[200:203], v6 offset:26624
    ds_read_b64 v[40:41], v9 offset:32768
    ds_read_b64 v[42:43], v9 offset:33792
    ds_read_b128 v[204:207], v6 offset:27648
    ds_read_b64 v[44:45], v9 offset:36864
    ds_read_b64 v[46:47], v9 offset:37888
    s_waitcnt lgkmcnt(6)
    v_mfma_f32_32x32x16_bf16 v[160:175], v[192:195], v[32:35], v[160:175]
    v_mfma_f32_32x32x16_bf16 v[160:175], v[196:199], v[36:39], v[160:175]
    s_waitcnt lgkmcnt(0)
    v_mfma_f32_32x32x16_bf16 v[160:175], v[200:203], v[40:43], v[160:175]
    v_mfma_f32_32x32x16_bf16 v[160:175], v[204:207], v[44:47], v[160:175]
    s_setprio 0
    v_lshlrev_b32 v228, 16, v178
    v_and_b32 v229, 0xffff0000, v178
    v_lshlrev_b32 v230, 16, v179
    v_and_b32 v231, 0xffff0000, v179
    v_mul_f32 v232, v228, v220
    v_mul_f32 v233, v229, v221
    v_mul_f32 v234, v230, v222
    v_mul_f32 v235, v231, v223
    v_add_f32 v184, v184, v228
    v_fmac_f32 v185, v228, v228
    v_add_f32 v186, v186, v232
    v_fmac_f32 v187, v232, v232
    v_fmac_f32 v188, v232, v220
    v_fmac_f32 v189, v232, v240
    v_add_f32 v184, v184, v229
    v_fmac_f32 v185, v229, v229
    v_add_f32 v186, v186, v233
    v_fmac_f32 v187, v233, v233
    v_fmac_f32 v188, v233, v221
    v_fmac_f32 v189, v233, v241
    v_add_f32 v184, v184, v230
    v_fmac_f32 v185, v230, v230
    v_add_f32 v186, v186, v234
    v_fmac_f32 v187, v234, v234
    v_fmac_f32 v188, v234, v222
    v_fmac_f32 v189, v234, v242
    v_add_f32 v184, v184, v231
    v_fmac_f32 v185, v231, v231
    v_add_f32 v186, v186, v235
    v_fmac_f32 v187, v235, v235
    v_fmac_f32 v188, v235, v223
    v_fmac_f32 v189, v235, v243
    s_waitcnt vmcnt(13)
    s_barrier
    s_add_u32 m0, s67, 24576
    s_add_u32 s69, s61, 1835008
    buffer_load_dwordx4 v1, s[24:27], s69 offen  lds
    s_add_u32 m0, s67, 32768
    s_add_u32 s69, s62, 1835008
    buffer_load_dwordx4 v1, s[24:27], s69 offen  lds
    s_add_u32 m0, s67, 40960
    s_add_u32 s69, s63, 28672
    buffer_load_dwordx4 v1, s[28:31], s69 offen  lds
    s_setprio 1
    ds_read_b128 v[192:195], v7 offset:0
    ds_read_b64 v[48:49], v10 offset:0
    ds_read_b64 v[50:51], v10 offset:1024
    ds_read_b128 v[196:199], v7 offset:1024
    ds_read_b64 v[52:53], v10 offset:4096
    ds_read_b64 v[54:55], v10 offset:5120
    ds_read_b128 v[200:203], v7 offset:2048
    ds_read_b64 v[56:57], v10 offset:8192
    ds_read_b64 v[58:59], v10 offset:9216
    ds_read_b128 v[204:207], v7 offset:3072
    ds_read_b64 v[60:61], v10 offset:12288
    ds_read_b64 v[62:63], v10 offset:13312
    s_waitcnt lgkmcnt(6)
    v_mfma_f32_32x32x16_bf16 v[160:175], v[192:195], v[48:51], v[160:175]
    v_mfma_f32_32x32x16_bf16 v[160:175], v[196:199], v[52:55], v[160:175]
    s_waitcnt lgkmcnt(0)
    v_mfma_f32_32x32x16_bf16 v[160:175], v[200:203], v[56:59], v[160:175]
    v_mfma_f32_32x32x16_bf16 v[160:175], v[204:207], v[60:63], v[160:175]
    s_setprio 0
    s_cmp_ge_u32 s52, 2
    s_cbranch_scc1 L_km_s3
    v_lshlrev_b32 v228, 16, v180
    v_and_b32 v229, 0xffff0000, v180
    v_lshlrev_b32 v230, 16, v181
    v_and_b32 v231, 0xffff0000, v181
    v_mul_f32 v232, v228, v224
    v_mul_f32 v233, v229, v225
    v_mul_f32 v234, v230, v226
    v_mul_f32 v235, v231, v227
    v_add_f32 v184, v184, v228
    v_fmac_f32 v185, v228, v228
    v_add_f32 v186, v186, v232
    v_fmac_f32 v187, v232, v232
    v_fmac_f32 v188, v232, v224
    v_fmac_f32 v189, v232, v244
    v_add_f32 v184, v184, v229
    v_fmac_f32 v185, v229, v229
    v_add_f32 v186, v186, v233
    v_fmac_f32 v187, v233, v233
    v_fmac_f32 v188, v233, v225
    v_fmac_f32 v189, v233, v245
    v_add_f32 v184, v184, v230
    v_fmac_f32 v185, v230, v230
    v_add_f32 v186, v186, v234
    v_fmac_f32 v187, v234, v234
    v_fmac_f32 v188, v234, v226
    v_fmac_f32 v189, v234, v246
    v_add_f32 v184, v184, v231
    v_fmac_f32 v185, v231, v231
    v_add_f32 v186, v186, v235
    v_fmac_f32 v187, v235, v235
    v_fmac_f32 v188, v235, v227
    v_fmac_f32 v189, v235, v247
L_km_s3:
    v_add_f32_dpp v184, v184, v184 row_ror:8 row_mask:0xf bank_mask:0xf
    v_add_f32_dpp v185, v185, v185 row_ror:8 row_mask:0xf bank_mask:0xf
    v_add_f32_dpp v186, v186, v186 row_ror:8 row_mask:0xf bank_mask:0xf
    v_add_f32_dpp v187, v187, v187 row_ror:8 row_mask:0xf bank_mask:0xf
    v_add_f32_dpp v188, v188, v188 row_ror:8 row_mask:0xf bank_mask:0xf
    v_add_f32_dpp v189, v189, v189 row_ror:8 row_mask:0xf bank_mask:0xf
    v_mov_b32 v228, v184
    v_mov_b32 v229, v185
    v_mov_b32 v230, v186
    v_mov_b32 v231, v187
    v_mov_b32 v232, v188
    v_mov_b32 v233, v189
    v_permlane16_swap_b32 v184, v228
    v_permlane16_swap_b32 v185, v229
    v_permlane16_swap_b32 v186, v230
    v_permlane16_swap_b32 v187, v231
    v_permlane16_swap_b32 v188, v232
    v_permlane16_swap_b32 v189, v233
    v_add_f32 v184, v184, v228
    v_add_f32 v185, v185, v229
    v_add_f32 v186, v186, v230
    v_add_f32 v187, v187, v231
    v_add_f32 v188, v188, v232
    v_add_f32 v189, v189, v233
    v_mov_b32 v228, v184
    v_mov_b32 v229, v185
    v_mov_b32 v230, v186
    v_mov_b32 v231, v187
    v_mov_b32 v232, v188
    v_mov_b32 v233, v189
    v_permlane32_swap_b32 v184, v228
    v_permlane32_swap_b32 v185, v229
    v_permlane32_swap_b32 v186, v230
    v_permlane32_swap_b32 v187, v231
    v_permlane32_swap_b32 v188, v232
    v_permlane32_swap_b32 v189, v233
    v_add_f32 v184, v184, v228
    v_add_f32 v185, v185, v229
    v_add_f32 v186, v186, v230
    v_add_f32 v187, v187, v231
    v_add_f32 v188, v188, v232
    v_add_f32 v189, v189, v233
    s_lshl_b32 s59, s52, 8
    s_add_u32 s59, s59, 156672
    v_lshl_add_u32 v228, v1, 1, s59
    s_mov_b64 exec, 0xff
    ds_write_b128 v228, v[184:187]
    ds_write_b64 v228, v[188:189] offset:16
    s_mov_b64 exec, -1
    s_waitcnt lgkmcnt(0)
    s_waitcnt vmcnt(13)
    s_barrier
    s_add_u32 m0, s67, 49152
    s_add_u32 s69, s61, 2097152
    buffer_load_dwordx4 v1, s[24:27], s69 offen  lds
    s_add_u32 m0, s67, 57344
    s_add_u32 s69, s62, 2097152
    buffer_load_dwordx4 v1, s[24:27], s69 offen  lds
    s_add_u32 m0, s67, 65536
    s_add_u32 s69, s63, 32768
    buffer_load_dwordx4 v1, s[28:31], s69 offen  lds
    s_setprio 1
    ds_read_b128 v[192:195], v7 offset:24576
    ds_read_b64 v[64:65], v10 offset:24576
    ds_read_b64 v[66:67], v10 offset:25600
    ds_read_b128 v[196:199], v7 offset:25600
    ds_read_b64 v[68:69], v10 offset:28672
    ds_read_b64 v[70:71], v10 offset:29696
    ds_read_b128 v[200:203], v7 offset:26624
    ds_read_b64 v[72:73], v10 offset:32768
    ds_read_b64 v[74:75], v10 offset:33792
    ds_read_b128 v[204:207], v7 offset:27648
    ds_read_b64 v[76:77], v10 offset:36864
    ds_read_b64 v[78:79], v10 offset:37888
    s_waitcnt lgkmcnt(6)
    v_mfma_f32_32x32x16_bf16 v[160:175], v[192:195], v[64:67], v[160:175]
    v_mfma_f32_32x32x16_bf16 v[160:175], v[196:199], v[68:71], v[160:175]
    s_waitcnt lgkmcnt(0)
    v_mfma_f32_32x32x16_bf16 v[160:175], v[200:203], v[72:75], v[160:175]
    v_mfma_f32_32x32x16_bf16 v[160:175], v[204:207], v[76:79], v[160:175]
    s_setprio 0
    s_cmp_lg_u32 s52, 4
    s_cbranch_scc1 L_km_s4
    v_lshlrev_b32 v228, 1, v1
    v_add_u32 v228, 156672, v228
    ds_read_b128 v[184:187], v228
    ds_read_b64 v[188:189], v228 offset:16
    s_waitcnt lgkmcnt(0)
    v_add_f32_dpp v184, v184, v184 row_ror:8 row_mask:0xf bank_mask:0xf
    v_add_f32_dpp v185, v185, v185 row_ror:8 row_mask:0xf bank_mask:0xf
    v_add_f32_dpp v186, v186, v186 row_ror:8 row_mask:0xf bank_mask:0xf
    v_add_f32_dpp v187, v187, v187 row_ror:8 row_mask:0xf bank_mask:0xf
    v_add_f32_dpp v188, v188, v188 row_ror:8 row_mask:0xf bank_mask:0xf
    v_add_f32_dpp v189, v189, v189 row_ror:8 row_mask:0xf bank_mask:0xf
    v_mov_b32 v228, v184
    v_mov_b32 v229, v185
    v_mov_b32 v230, v186
    v_mov_b32 v231, v187
    v_mov_b32 v232, v188
    v_mov_b32 v233, v189
    v_permlane16_swap_b32 v184, v228
    v_permlane16_swap_b32 v185, v229
    v_permlane16_swap_b32 v186, v230
    v_permlane16_swap_b32 v187, v231
    v_permlane16_swap_b32 v188, v232
    v_permlane16_swap_b32 v189, v233
    v_add_f32 v184, v184, v228
    v_add_f32 v185, v185, v229
    v_add_f32 v186, v186, v230
    v_add_f32 v187, v187, v231
    v_add_f32 v188, v188, v232
    v_add_f32 v189, v189, v233
    v_mov_b32 v228, v184
    v_mov_b32 v229, v185
    v_mov_b32 v230, v186
    v_mov_b32 v231, v187
    v_mov_b32 v232, v188
    v_mov_b32 v233, v189
    v_permlane32_swap_b32 v184, v228
    v_permlane32_swap_b32 v185, v229
    v_permlane32_swap_b32 v186, v230
    v_permlane32_swap_b32 v187, v231
    v_permlane32_swap_b32 v188, v232
    v_permlane32_swap_b32 v189, v233
    v_add_f32 v184, v184, v228
    v_add_f32 v185, v185, v229
    v_add_f32 v186, v186, v230
    v_add_f32 v187, v187, v231
    v_add_f32 v188, v188, v232
    v_add_f32 v189, v189, v233
    v_mul_f32 v220, 0x3ae38e39, v184
    v_mul_f32 v222, 0x3ae38e39, v185
    v_fma_f32 v222, -v220, v220, v222
    v_max_f32 v222, 0, v222
    v_add_f32 v222, 0x3727c5ac, v222
    v_rsq_f32 v221, v222
    v_sqrt_f32 v213, v222
    v_fma_f32 v186, -v220, s14, v186
    v_fma_f32 v189, -v220, s13, v189
    v_mul_f32 v223, s12, v220
    v_fma_f32 v223, -2.0, v188, v223
    v_fma_f32 v187, v220, v223, v187
    v_mov_b32 v222, s18
    v_fma_f32 v222, v221, v186, v222
    v_mul_f32 v222, 0x3ae38e39, v222
    v_mul_f32 v187, v187, v221
    v_fma_f32 v187, 2.0, v189, v187
    v_mov_b32 v223, s17
    v_fma_f32 v223, v221, v187, v223
    v_mul_f32 v223, 0x3ae38e39, v223
    v_fma_f32 v223, -v222, v222, v223
    v_max_f32 v223, 0, v223
    v_add_f32 v223, 0x3727c5ac, v223
    v_sqrt_f32 v223, v223
    v_sub_f32 v212, 0, v220
    v_mul_f32 v216, v222, v213
    v_sub_f32 v216, 0, v216
    v_mul_f32 v217, v213, v223
    v_mov_b32 v214, s10
    v_mov_b32 v215, s11
    v_mov_b32 v218, s10
    v_mov_b32 v219, s11
    v_lshlrev_b32 v228, 1, v1
    s_lshl_b32 s59, s75, 5
    s_mov_b64 exec, 0xff
    buffer_store_dwordx4 v[212:215], v228, s[40:43], s59 offen sc1
    buffer_store_dwordx4 v[216:219], v228, s[40:43], s59 offen offset:16 sc1
    s_mov_b64 exec, -1
L_km_s4:
    s_waitcnt vmcnt(12)
    s_barrier
    s_add_u32 m0, s68, 73728
    s_add_u32 s69, s64, 75776
    buffer_load_dwordx4 v1, s[28:31], s69 offen offset:0  lds
    buffer_load_dwordx4 v1, s[28:31], s69 offen offset:1024  lds
    buffer_load_dwordx4 v1, s[28:31], s69 offen offset:2048  lds
    s_setprio 1
    ds_read_b128 v[192:195], v8 offset:0
    ds_read_b64 v[80:81], v11 offset:0
    ds_read_b64 v[82:83], v11 offset:1024
    ds_read_b128 v[196:199], v8 offset:1024
    ds_read_b64 v[84:85], v11 offset:4096
    ds_read_b64 v[86:87], v11 offset:5120
    ds_read_b128 v[200:203], v8 offset:2048
    ds_read_b64 v[88:89], v11 offset:8192
    ds_read_b64 v[90:91], v11 offset:9216
    ds_read_b128 v[204:207], v8 offset:3072
    ds_read_b64 v[92:93], v11 offset:12288
    ds_read_b64 v[94:95], v11 offset:13312
    s_waitcnt lgkmcnt(6)
    v_mfma_f32_32x32x16_bf16 v[160:175], v[192:195], v[80:83], v[160:175]
    v_mfma_f32_32x32x16_bf16 v[160:175], v[196:199], v[84:87], v[160:175]
    s_waitcnt lgkmcnt(0)
    v_mfma_f32_32x32x16_bf16 v[160:175], v[200:203], v[88:91], v[160:175]
    v_mfma_f32_32x32x16_bf16 v[160:175], v[204:207], v[92:95], v[160:175]
    s_setprio 0
    s_waitcnt vmcnt(12)
    s_barrier
    s_add_u32 m0, s68, 98304
    s_add_u32 s69, s64, 88064
    buffer_load_dwordx4 v1, s[28:31], s69 offen offset:0  lds
    buffer_load_dwordx4 v1, s[28:31], s69 offen offset:1024  lds
    buffer_load_dwordx4 v1, s[28:31], s69 offen offset:2048  lds
    s_setprio 1
    ds_read_b128 v[192:195], v8 offset:24576
    ds_read_b64 v[96:97], v11 offset:24576
    ds_read_b64 v[98:99], v11 offset:25600
    ds_read_b128 v[196:199], v8 offset:25600
    ds_read_b64 v[100:101], v11 offset:28672
    ds_read_b64 v[102:103], v11 offset:29696
    ds_read_b128 v[200:203], v8 offset:26624
    ds_read_b64 v[104:105], v11 offset:32768
    ds_read_b64 v[106:107], v11 offset:33792
    ds_read_b128 v[204:207], v8 offset:27648
    ds_read_b64 v[108:109], v11 offset:36864
    ds_read_b64 v[110:111], v11 offset:37888
    s_waitcnt lgkmcnt(6)
    v_mfma_f32_32x32x16_bf16 v[160:175], v[192:195], v[96:99], v[160:175]
    v_mfma_f32_32x32x16_bf16 v[160:175], v[196:199], v[100:103], v[160:175]
    s_waitcnt lgkmcnt(0)
    v_mfma_f32_32x32x16_bf16 v[160:175], v[200:203], v[104:107], v[160:175]
    v_mfma_f32_32x32x16_bf16 v[160:175], v[204:207], v[108:111], v[160:175]
    s_setprio 0
    s_waitcnt vmcnt(12)
    s_barrier
    s_add_u32 m0, s68, 122880
    s_add_u32 s69, s64, 100352
    buffer_load_dwordx4 v1, s[28:31], s69 offen offset:0  lds
    buffer_load_dwordx4 v1, s[28:31], s69 offen offset:1024  lds
    buffer_load_dwordx4 v1, s[28:31], s69 offen offset:2048  lds
    s_setprio 1
    ds_read_b128 v[192:195], v6 offset:0
    ds_read_b64 v[112:113], v9 offset:0
    ds_read_b64 v[114:115], v9 offset:1024
    ds_read_b128 v[196:199], v6 offset:1024
    ds_read_b64 v[116:117], v9 offset:4096
    ds_read_b64 v[118:119], v9 offset:5120
    ds_read_b128 v[200:203], v6 offset:2048
    ds_read_b64 v[120:121], v9 offset:8192
    ds_read_b64 v[122:123], v9 offset:9216
    ds_read_b128 v[204:207], v6 offset:3072
    ds_read_b64 v[124:125], v9 offset:12288
    ds_read_b64 v[126:127], v9 offset:13312
    s_waitcnt lgkmcnt(6)
    v_mfma_f32_32x32x16_bf16 v[160:175], v[192:195], v[112:115], v[160:175]
    v_mfma_f32_32x32x16_bf16 v[160:175], v[196:199], v[116:119], v[160:175]
    s_waitcnt lgkmcnt(0)
    v_mfma_f32_32x32x16_bf16 v[160:175], v[200:203], v[120:123], v[160:175]
    v_mfma_f32_32x32x16_bf16 v[160:175], v[204:207], v[124:127], v[160:175]
    s_setprio 0
    s_add_u32 s59, s54, 1
    s_and_b32 s59, s59, 3
    s_and_b32 s60, s2, 0xfffffffc
    s_or_b32 s59, s59, s60
    s_mul_i32 s59, s59, 72
    s_add_u32 s59, s59, 0
    s_lshl_b32 s60, s56, 1
    s_add_u32 s59, s59, s60
    s_add_u32 s59, s59, s57
    s_lshl_b32 s15, s59, 10
    s_add_u32 s59, s54, 2
    s_and_b32 s59, s59, 3
    s_and_b32 s60, s2, 0xfffffffc
    s_or_b32 s59, s59, s60
    s_mul_i32 s59, s59, 72
    s_add_u32 s59, s59, 18
    s_lshl_b32 s60, s56, 1
    s_add_u32 s59, s59, s60
    s_add_u32 s59, s59, s57
    s_lshl_b32 s19, s59, 10
    s_add_u32 s59, s54, 3
    s_and_b32 s59, s59, 3
    s_and_b32 s60, s2, 0xfffffffc
    s_or_b32 s59, s59, s60
    s_mul_i32 s59, s59, 72
    s_add_u32 s59, s59, 36
    s_lshl_b32 s60, s56, 1
    s_add_u32 s59, s59, s60
    s_add_u32 s59, s59, s57
    s_lshl_b32 s23, s59, 10
    s_and_b32 s60, s2, 0xfffffffc
    s_or_b32 s59, s56, s60
    s_lshl_b32 s59, s59, 2
    s_sub_u32 s60, s56, s54
    s_add_u32 s60, s60, 3
    s_and_b32 s60, s60, 3
    s_add_u32 s59, s59, s60
    s_mul_i32 s59, s59, 18
    s_add_u32 s59, s59, 16
    s_add_u32 s59, s59, s57
    s_lshl_b32 s22, s59, 10
    s_add_u32 s48, s4, 0x2c5c000
    s_addc_u32 s49, s5, 0
    s_mov_b32 s50, 0x1200000
    s_mov_b32 s51, 0x20000
    v_and_b32 v228, 0x1f0, v1
    v_lshlrev_b32 v228, 1, v228
    s_lshl_b32 s75, s53, 2
    s_add_u32 s75, s75, s56
    s_lshl_b32 s75, s75, 10
    buffer_load_dwordx4 v[212:215], v228, s[40:43], s75 offen sc1
    buffer_load_dwordx4 v[216:219], v228, s[40:43], s75 offen offset:16 sc1
    s_waitcnt vmcnt(14)
    s_barrier
    s_add_u32 m0, s68, 0
    s_add_u32 s69, s64, 151552
    buffer_load_dwordx4 v1, s[28:31], s69 offen offset:0  lds
    buffer_load_dwordx4 v1, s[28:31], s69 offen offset:1024  lds
    buffer_load_dwordx4 v1, s[28:31], s69 offen offset:2048  lds
    s_setprio 1
    ds_read_b128 v[192:195], v6 offset:24576
    ds_read_b64 v[128:129], v9 offset:24576
    ds_read_b64 v[130:131], v9 offset:25600
    ds_read_b128 v[196:199], v6 offset:25600
    ds_read_b64 v[132:133], v9 offset:28672
    ds_read_b64 v[134:135], v9 offset:29696
    ds_read_b128 v[200:203], v6 offset:26624
    ds_read_b64 v[136:137], v9 offset:32768
    ds_read_b64 v[138:139], v9 offset:33792
    ds_read_b128 v[204:207], v6 offset:27648
    ds_read_b64 v[140:141], v9 offset:36864
    ds_read_b64 v[142:143], v9 offset:37888
    s_waitcnt lgkmcnt(6)
    v_mfma_f32_32x32x16_bf16 v[160:175], v[192:195], v[128:131], v[160:175]
    v_mfma_f32_32x32x16_bf16 v[160:175], v[196:199], v[132:135], v[160:175]
    s_waitcnt lgkmcnt(0)
    v_mfma_f32_32x32x16_bf16 v[160:175], v[200:203], v[136:139], v[160:175]
    v_mfma_f32_32x32x16_bf16 v[160:175], v[204:207], v[140:143], v[160:175]
    s_setprio 0
    s_waitcnt vmcnt(11)
    s_barrier
    s_setprio 1
    ds_read_b128 v[192:195], v7 offset:0
    ds_read_b64 v[144:145], v10 offset:0
    ds_read_b64 v[146:147], v10 offset:1024
    ds_read_b128 v[196:199], v7 offset:1024
    ds_read_b64 v[148:149], v10 offset:4096
    ds_read_b64 v[150:151], v10 offset:5120
    ds_read_b128 v[200:203], v7 offset:2048
    ds_read_b64 v[152:153], v10 offset:8192
    ds_read_b64 v[154:155], v10 offset:9216
    ds_read_b128 v[204:207], v7 offset:3072
    ds_read_b64 v[156:157], v10 offset:12288
    ds_read_b64 v[158:159], v10 offset:13312
    s_waitcnt lgkmcnt(6)
    v_mfma_f32_32x32x16_bf16 v[160:175], v[192:195], v[144:147], v[160:175]
    v_mfma_f32_32x32x16_bf16 v[160:175], v[196:199], v[148:151], v[160:175]
    s_waitcnt lgkmcnt(0)
    v_mfma_f32_32x32x16_bf16 v[160:175], v[200:203], v[152:155], v[160:175]
    v_mfma_f32_32x32x16_bf16 v[160:175], v[204:207], v[156:159], v[160:175]
    s_setprio 0
    s_cmp_eq_u32 s57, 1
    s_cbranch_scc0 L_km_kernel_cb_1
    s_waitcnt vmcnt(8)
    s_barrier
L_km_kernel_cb_1:
    s_add_u32 m0, s68, 24576
    s_add_u32 s69, s64, 163840
    buffer_load_dwordx4 v1, s[28:31], s69 offen offset:0  lds
    buffer_load_dwordx4 v1, s[28:31], s69 offen offset:1024  lds
    buffer_load_dwordx4 v1, s[28:31], s69 offen offset:2048  lds
    s_waitcnt vmcnt(6)
L_km_kernel_asp_3:
    v_cmp_ne_u64 s[76:77], s[10:11], v[214:215]
    v_cmp_ne_u64 s[78:79], s[10:11], v[218:219]
    s_nop 0
    s_or_b64 s[76:77], s[76:77], s[78:79]
    s_cmp_eq_u64 s[76:77], 0
    s_cbranch_scc1 L_km_kernel_aok_2
    s_sleep 1
    buffer_load_dwordx4 v[212:215], v228, s[40:43], s75 offen sc1
    buffer_load_dwordx4 v[216:219], v228, s[40:43], s75 offen offset:16 sc1
    s_waitcnt vmcnt(0)
    s_sub_u32 s3, s3, 1
    s_cbranch_scc0 L_km_kernel_asp_3
L_km_kernel_aok_2:
    v_cvt_pk_bf16_f32 v220, v212, v212
    v_and_b32 v220, 0xffff0000, v220
    v_sub_f32 v224, v212, v220
    v_cvt_pk_bf16_f32 v221, v213, v213
    v_and_b32 v221, 0xffff0000, v221
    v_sub_f32 v225, v213, v221
    v_cvt_pk_bf16_f32 v222, v216, v216
    v_and_b32 v222, 0xffff0000, v222
    v_sub_f32 v226, v216, v222
    v_cvt_pk_bf16_f32 v223, v217, v217
    v_and_b32 v223, 0xffff0000, v223
    v_sub_f32 v227, v217, v223
    v_rcp_f32 v2, v217
    v_cvt_pk_bf16_f32 v214, v227, v227
    v_and_b32 v214, 0xffff0000, v214
    v_sub_f32 v215, v227, v214
    v_cvt_pk_bf16_f32 v252, v220, v220
    v_cvt_pk_bf16_f32 v253, v224, v221
    v_cvt_pk_bf16_f32 v254, v221, v225
    v_cvt_pk_bf16_f32 v255, v222, v222
    v_cvt_pk_bf16_f32 v230, v226, v223
    v_cvt_pk_bf16_f32 v231, v214, v215
    v_mov_b32 v232, 0x200
    v_cmp_gt_u32 s[76:77], v232, v1
    v_mul_f32 v3, v2, v2
    v_mul_f32 v3, v3, v2
    v_cndmask_b32 v252, v230, v252, s[76:77]
    v_cndmask_b32 v253, v231, v253, s[76:77]
    v_cndmask_b32 v254, 0, v254, s[76:77]
    v_cndmask_b32 v255, 0, v255, s[76:77]
    v_mul_f32 v3, 0xbdd2d3e8, v3
    v_mul_f32 v2, 0xc0135761, v2
    ds_read_b128 v[192:195], v15 offset:0
    ds_read_b128 v[196:199], v13 offset:24576
    ds_read_b128 v[200:203], v13 offset:25600
    ds_read_b128 v[204:207], v13 offset:26624
    ds_read_b128 v[208:211], v13 offset:27648
    ds_read_b128 v[236:239], v13 offset:28672
    ds_read_b128 v[240:243], v13 offset:29696
    ds_read_b128 v[244:247], v13 offset:30720
    ds_read_b128 v[248:251], v13 offset:31744
    s_cmp_eq_u32 s57, 0
    s_cbranch_scc0 L_km_kernel_cb_4
    s_barrier
L_km_kernel_cb_4:
    s_setprio 1
    s_waitcnt lgkmcnt(7)
    v_mfma_f32_32x32x16_bf16 v[160:175], v[192:195], v[252:255], v[160:175]
    ds_read_b128 v[192:195], v13 offset:32768
    v_mfma_f32_32x32x16_bf16 v[176:191], v[196:199], v[16:19], 0
    ds_read_b128 v[196:199], v13 offset:33792
    s_waitcnt lgkmcnt(7)
    v_mfma_f32_32x32x16_bf16 v[176:191], v[200:203], v[20:23], v[176:191]
    ds_read_b128 v[200:203], v13 offset:34816
    v_mfma_f32_32x32x16_bf16 v[176:191], v[204:207], v[24:27], v[176:191]
    ds_read_b128 v[204:207], v13 offset:35840
    s_waitcnt lgkmcnt(7)
    v_mfma_f32_32x32x16_bf16 v[176:191], v[208:211], v[28:31], v[176:191]
    v_mfma_f32_32x32x16_bf16 v[176:191], v[236:239], v[32:35], v[176:191]
    s_waitcnt lgkmcnt(5)
    v_mfma_f32_32x32x16_bf16 v[176:191], v[240:243], v[36:39], v[176:191]
    v_mfma_f32_32x32x16_bf16 v[176:191], v[244:247], v[40:43], v[176:191]
    s_waitcnt lgkmcnt(3)
    v_mfma_f32_32x32x16_bf16 v[176:191], v[248:251], v[44:47], v[176:191]
    v_mfma_f32_32x32x16_bf16 v[176:191], v[192:195], v[48:51], v[176:191]
    s_waitcnt lgkmcnt(1)
    v_mfma_f32_32x32x16_bf16 v[176:191], v[196:199], v[52:55], v[176:191]
    v_mfma_f32_32x32x16_bf16 v[176:191], v[200:203], v[56:59], v[176:191]
    s_waitcnt lgkmcnt(0)
    v_mfma_f32_32x32x16_bf16 v[176:191], v[204:207], v[60:63], v[176:191]
    s_setprio 0
    s_cmp_eq_u32 s57, 1
    s_cbranch_scc0 L_km_kernel_cb_5
    s_barrier
L_km_kernel_cb_5:
    s_lshl_b32 s59, s57, 10
    v_add_u32 v6, s59, v1
    s_xor_b32 s59, s59, 1024
    v_add_u32 v7, s59, v1
    v_mov_b32 v9, v1
    v_add_u32 v10, 49152, v1
    v_add_u32 v11, 98304, v1
    s_add_u32 m0, s68, 49152
    s_add_u32 s69, s64, 176128
    buffer_load_dwordx4 v1, s[28:31], s69 offen offset:0  lds
    v_mul_f32 v212, v160, v160
    v_mul_f32 v213, v161, v161
    v_mul_f32 v214, v162, v162
    v_mul_f32 v215, v163, v163
    v_fma_f32 v212, v212, v3, v2
    v_fma_f32 v213, v213, v3, v2
    v_fma_f32 v214, v214, v3, v2
    v_fma_f32 v215, v215, v3, v2
    v_mul_f32 v216, v160, v212
    v_mul_f32 v217, v161, v213
    v_mul_f32 v218, v162, v214
    v_mul_f32 v219, v163, v215
    v_exp_f32 v216, v216
    v_exp_f32 v217, v217
    v_exp_f32 v218, v218
    v_exp_f32 v219, v219
    v_add_f32 v216, 1.0, v216
    v_add_f32 v217, 1.0, v217
    v_add_f32 v218, 1.0, v218
    v_add_f32 v219, 1.0, v219
    v_rcp_f32 v216, v216
    v_rcp_f32 v217, v217
    buffer_load_dwordx4 v1, s[28:31], s69 offen offset:1024  lds
    v_rcp_f32 v218, v218
    v_rcp_f32 v219, v219
    v_mul_f32 v216, v160, v216
    v_mul_f32 v217, v161, v217
    v_mul_f32 v218, v162, v218
    v_mul_f32 v219, v163, v219
    v_cvt_pk_bf16_f32 v228, v216, v217
    v_cvt_pk_bf16_f32 v229, v218, v219
    v_mul_f32 v220, v164, v164
    v_mul_f32 v221, v165, v165
    v_mul_f32 v222, v166, v166
    v_mul_f32 v223, v167, v167
    v_fma_f32 v220, v220, v3, v2
    v_fma_f32 v221, v221, v3, v2
    v_fma_f32 v222, v222, v3, v2
    v_fma_f32 v223, v223, v3, v2
    v_mul_f32 v224, v164, v220
    v_mul_f32 v225, v165, v221
    v_mul_f32 v226, v166, v222
    v_mul_f32 v227, v167, v223
    v_exp_f32 v224, v224
    v_exp_f32 v225, v225
    buffer_load_dwordx4 v1, s[28:31], s69 offen offset:2048  lds
    v_exp_f32 v226, v226
    v_exp_f32 v227, v227
    v_add_f32 v224, 1.0, v224
    v_add_f32 v225, 1.0, v225
    v_add_f32 v226, 1.0, v226
    v_add_f32 v227, 1.0, v227
    v_rcp_f32 v224, v224
    v_rcp_f32 v225, v225
    v_rcp_f32 v226, v226
    v_rcp_f32 v227, v227
    v_mul_f32 v224, v164, v224
    v_mul_f32 v225, v165, v225
    v_mul_f32 v226, v166, v226
    v_mul_f32 v227, v167, v227
    v_cvt_pk_bf16_f32 v230, v224, v225
    v_cvt_pk_bf16_f32 v231, v226, v227
    v_mul_f32 v212, v168, v168
    v_mul_f32 v213, v169, v169
    v_mul_f32 v214, v170, v170
    v_mul_f32 v215, v171, v171
    ds_read_b128 v[192:195], v14 offset:0
    ds_read_b128 v[196:199], v14 offset:1024
    ds_read_b128 v[200:203], v14 offset:2048
    ds_read_b128 v[204:207], v14 offset:3072
    ds_read_b128 v[208:211], v14 offset:4096
    ds_read_b128 v[236:239], v14 offset:5120
    ds_read_b128 v[240:243], v14 offset:6144
    ds_read_b128 v[244:247], v14 offset:7168
    ds_read_b128 v[248:251], v14 offset:8192
    s_cmp_eq_u32 s57, 0
    s_cbranch_scc0 L_km_kernel_cb_6
    s_barrier
L_km_kernel_cb_6:
    s_setprio 1
    s_waitcnt lgkmcnt(7)
    v_mfma_f32_32x32x16_bf16 v[176:191], v[192:195], v[64:67], v[176:191]
    ds_read_b128 v[192:195], v14 offset:9216
    v_mfma_f32_32x32x16_bf16 v[176:191], v[196:199], v[68:71], v[176:191]
    ds_read_b128 v[196:199], v14 offset:10240
    s_waitcnt lgkmcnt(7)
    v_mfma_f32_32x32x16_bf16 v[176:191], v[200:203], v[72:75], v[176:191]
    ds_read_b128 v[200:203], v14 offset:11264
    v_mfma_f32_32x32x16_bf16 v[176:191], v[204:207], v[76:79], v[176:191]
    s_waitcnt lgkmcnt(6)
    v_mfma_f32_32x32x16_bf16 v[176:191], v[208:211], v[80:83], v[176:191]
    v_mfma_f32_32x32x16_bf16 v[176:191], v[236:239], v[84:87], v[176:191]
    s_waitcnt lgkmcnt(4)
    v_mfma_f32_32x32x16_bf16 v[176:191], v[240:243], v[88:91], v[176:191]
    v_mfma_f32_32x32x16_bf16 v[176:191], v[244:247], v[92:95], v[176:191]
    s_waitcnt lgkmcnt(2)
    v_mfma_f32_32x32x16_bf16 v[176:191], v[248:251], v[96:99], v[176:191]
    v_mfma_f32_32x32x16_bf16 v[176:191], v[192:195], v[100:103], v[176:191]
    s_waitcnt lgkmcnt(0)
    v_mfma_f32_32x32x16_bf16 v[176:191], v[196:199], v[104:107], v[176:191]
    v_mfma_f32_32x32x16_bf16 v[176:191], v[200:203], v[108:111], v[176:191]
    s_setprio 0
    s_cmp_eq_u32 s57, 1
    s_cbranch_scc0 L_km_kernel_cb_7
    s_waitcnt vmcnt(6)
    s_barrier
L_km_kernel_cb_7:
    s_add_u32 m0, s68, 73728
    s_add_u32 s69, s64, 227328
    buffer_load_dwordx4 v1, s[28:31], s69 offen offset:0  lds
    v_fma_f32 v212, v212, v3, v2
    v_fma_f32 v213, v213, v3, v2
    v_fma_f32 v214, v214, v3, v2
    v_fma_f32 v215, v215, v3, v2
    v_mul_f32 v216, v168, v212
    v_mul_f32 v217, v169, v213
    v_mul_f32 v218, v170, v214
    v_mul_f32 v219, v171, v215
    v_exp_f32 v216, v216
    v_exp_f32 v217, v217
    v_exp_f32 v218, v218
    v_exp_f32 v219, v219
    v_add_f32 v216, 1.0, v216
    v_add_f32 v217, 1.0, v217
    v_add_f32 v218, 1.0, v218
    v_add_f32 v219, 1.0, v219
    v_rcp_f32 v216, v216
    v_rcp_f32 v217, v217
    v_rcp_f32 v218, v218
    v_rcp_f32 v219, v219
    v_mul_f32 v216, v168, v216
    buffer_load_dwordx4 v1, s[28:31], s69 offen offset:1024  lds
    v_mul_f32 v217, v169, v217
    v_mul_f32 v218, v170, v218
    v_mul_f32 v219, v171, v219
    v_cvt_pk_bf16_f32 v232, v216, v217
    v_cvt_pk_bf16_f32 v233, v218, v219
    v_mul_f32 v220, v172, v172
    v_mul_f32 v221, v173, v173
    v_mul_f32 v222, v174, v174
    v_mul_f32 v223, v175, v175
    v_fma_f32 v220, v220, v3, v2
    v_fma_f32 v221, v221, v3, v2
    v_fma_f32 v222, v222, v3, v2
    v_fma_f32 v223, v223, v3, v2
    v_mul_f32 v224, v172, v220
    v_mul_f32 v225, v173, v221
    v_mul_f32 v226, v174, v222
    v_mul_f32 v227, v175, v223
    v_exp_f32 v224, v224
    v_exp_f32 v225, v225
    v_exp_f32 v226, v226
    v_exp_f32 v227, v227
    buffer_load_dwordx4 v1, s[28:31], s69 offen offset:2048  lds
    v_add_f32 v224, 1.0, v224
    v_add_f32 v225, 1.0, v225
    v_add_f32 v226, 1.0, v226
    v_add_f32 v227, 1.0, v227
    v_rcp_f32 v224, v224
    v_rcp_f32 v225, v225
    v_rcp_f32 v226, v226
    v_rcp_f32 v227, v227
    v_mul_f32 v224, v172, v224
    v_mul_f32 v225, v173, v225
    v_mul_f32 v226, v174, v226
    v_mul_f32 v227, v175, v227
    v_cvt_pk_bf16_f32 v234, v224, v225
    v_cvt_pk_bf16_f32 v235, v226, v227
    s_add_u32 s71, s70, 0
    v_permlane16_swap_b32 v228, v232
    v_permlane16_swap_b32 v229, v233
    v_permlane16_swap_b32 v230, v234
    v_permlane16_swap_b32 v231, v235
    buffer_store_dwordx4 v[228:231], v1, s[36:39], s71 offen offset:0 sc1
    buffer_store_dwordx4 v[232:235], v1, s[36:39], s71 offen offset:1024 sc1
    ds_read_b128 v[192:195], v14 offset:24576
    ds_read_b128 v[196:199], v14 offset:25600
    ds_read_b128 v[200:203], v14 offset:26624
    ds_read_b128 v[204:207], v14 offset:27648
    ds_read_b128 v[208:211], v14 offset:28672
    ds_read_b128 v[236:239], v14 offset:29696
    ds_read_b128 v[240:243], v14 offset:30720
    ds_read_b128 v[244:247], v14 offset:31744
    ds_read_b128 v[248:251], v14 offset:32768
    s_cmp_eq_u32 s57, 0
    s_cbranch_scc0 L_km_kernel_cb_8
    s_waitcnt vmcnt(11)
    s_barrier
L_km_kernel_cb_8:
    s_setprio 1
    s_waitcnt lgkmcnt(7)
    v_mfma_f32_32x32x16_bf16 v[176:191], v[192:195], v[112:115], v[176:191]
    ds_read_b128 v[192:195], v14 offset:33792
    v_mfma_f32_32x32x16_bf16 v[176:191], v[196:199], v[116:119], v[176:191]
    ds_read_b128 v[196:199], v14 offset:34816
    s_waitcnt lgkmcnt(7)
    v_mfma_f32_32x32x16_bf16 v[176:191], v[200:203], v[120:123], v[176:191]
    ds_read_b128 v[200:203], v14 offset:35840
    v_mfma_f32_32x32x16_bf16 v[176:191], v[204:207], v[124:127], v[176:191]
    ds_read_b128 v[204:207], v15 offset:2048
    s_waitcnt lgkmcnt(7)
    v_mfma_f32_32x32x16_bf16 v[176:191], v[208:211], v[128:131], v[176:191]
    v_mfma_f32_32x32x16_bf16 v[176:191], v[236:239], v[132:135], v[176:191]
    s_waitcnt lgkmcnt(5)
    v_mfma_f32_32x32x16_bf16 v[176:191], v[240:243], v[136:139], v[176:191]
    v_mfma_f32_32x32x16_bf16 v[176:191], v[244:247], v[140:143], v[176:191]
    s_waitcnt lgkmcnt(3)
    v_mfma_f32_32x32x16_bf16 v[176:191], v[248:251], v[144:147], v[176:191]
    v_mfma_f32_32x32x16_bf16 v[176:191], v[192:195], v[148:151], v[176:191]
    s_waitcnt lgkmcnt(1)
    v_mfma_f32_32x32x16_bf16 v[176:191], v[196:199], v[152:155], v[176:191]
    v_mfma_f32_32x32x16_bf16 v[176:191], v[200:203], v[156:159], v[176:191]
    s_waitcnt lgkmcnt(0)
    v_mfma_f32_32x32x16_bf16 v[176:191], v[204:207], v[252:255], v[176:191]
    s_setprio 0
    s_cmp_eq_u32 s57, 1
    s_cbranch_scc0 L_km_kernel_cb_9
    s_waitcnt vmcnt(8)
    s_barrier
L_km_kernel_cb_9:
    s_add_u32 m0, s68, 98304
    s_add_u32 s69, s64, 239616
    buffer_load_dwordx4 v1, s[28:31], s69 offen offset:0  lds
    s_nop 5
    v_mul_f32 v212, v176, v176
    v_mul_f32 v213, v177, v177
    v_mul_f32 v214, v178, v178
    v_mul_f32 v215, v179, v179
    v_fma_f32 v212, v212, v3, v2
    v_fma_f32 v213, v213, v3, v2
    v_fma_f32 v214, v214, v3, v2
    v_fma_f32 v215, v215, v3, v2
    v_mul_f32 v216, v176, v212
    v_mul_f32 v217, v177, v213
    v_mul_f32 v218, v178, v214
    v_mul_f32 v219, v179, v215
    v_exp_f32 v216, v216
    v_exp_f32 v217, v217
    v_exp_f32 v218, v218
    buffer_load_dwordx4 v1, s[28:31], s69 offen offset:1024  lds
    v_exp_f32 v219, v219
    v_add_f32 v216, 1.0, v216
    v_add_f32 v217, 1.0, v217
    v_add_f32 v218, 1.0, v218
    v_add_f32 v219, 1.0, v219
    v_rcp_f32 v216, v216
    v_rcp_f32 v217, v217
    v_rcp_f32 v218, v218
    v_rcp_f32 v219, v219
    v_mul_f32 v216, v176, v216
    v_mul_f32 v217, v177, v217
    v_mul_f32 v218, v178, v218
    v_mul_f32 v219, v179, v219
    v_cvt_pk_bf16_f32 v228, v216, v217
    v_cvt_pk_bf16_f32 v229, v218, v219
    buffer_load_dwordx4 v1, s[28:31], s69 offen offset:2048  lds
    v_mul_f32 v220, v180, v180
    v_mul_f32 v221, v181, v181
    v_mul_f32 v222, v182, v182
    v_mul_f32 v223, v183, v183
    v_fma_f32 v220, v220, v3, v2
    v_fma_f32 v221, v221, v3, v2
    v_fma_f32 v222, v222, v3, v2
    v_fma_f32 v223, v223, v3, v2
    v_mul_f32 v224, v180, v220
    v_mul_f32 v225, v181, v221
    v_mul_f32 v226, v182, v222
    v_mul_f32 v227, v183, v223
    v_exp_f32 v224, v224
    ds_read_b128 v[192:195], v12 offset:0
    ds_read_b128 v[196:199], v12 offset:1024
    ds_read_b128 v[200:203], v12 offset:2048
    ds_read_b128 v[204:207], v12 offset:3072
    ds_read_b128 v[208:211], v12 offset:4096
    ds_read_b128 v[236:239], v12 offset:5120
    ds_read_b128 v[240:243], v12 offset:6144
    ds_read_b128 v[244:247], v12 offset:7168
    ds_read_b128 v[248:251], v12 offset:8192
    s_cmp_eq_u32 s57, 0
    s_cbranch_scc0 L_km_kernel_cb_10
    s_waitcnt vmcnt(11)
    s_barrier
L_km_kernel_cb_10:
    s_setprio 1
    s_waitcnt lgkmcnt(7)
    v_mfma_f32_32x32x16_bf16 v[160:175], v[192:195], v[16:19], 0
    ds_read_b128 v[192:195], v12 offset:9216
    v_mfma_f32_32x32x16_bf16 v[160:175], v[196:199], v[20:23], v[160:175]
    ds_read_b128 v[196:199], v12 offset:10240
    s_waitcnt lgkmcnt(7)
    v_mfma_f32_32x32x16_bf16 v[160:175], v[200:203], v[24:27], v[160:175]
    ds_read_b128 v[200:203], v12 offset:11264
    v_mfma_f32_32x32x16_bf16 v[160:175], v[204:207], v[28:31], v[160:175]
    s_waitcnt lgkmcnt(6)
    v_mfma_f32_32x32x16_bf16 v[160:175], v[208:211], v[32:35], v[160:175]
    v_mfma_f32_32x32x16_bf16 v[160:175], v[236:239], v[36:39], v[160:175]
    s_waitcnt lgkmcnt(4)
    v_mfma_f32_32x32x16_bf16 v[160:175], v[240:243], v[40:43], v[160:175]
    v_mfma_f32_32x32x16_bf16 v[160:175], v[244:247], v[44:47], v[160:175]
    s_waitcnt lgkmcnt(2)
    v_mfma_f32_32x32x16_bf16 v[160:175], v[248:251], v[48:51], v[160:175]
    v_mfma_f32_32x32x16_bf16 v[160:175], v[192:195], v[52:55], v[160:175]
    s_waitcnt lgkmcnt(0)
    v_mfma_f32_32x32x16_bf16 v[160:175], v[196:199], v[56:59], v[160:175]
    v_mfma_f32_32x32x16_bf16 v[160:175], v[200:203], v[60:63], v[160:175]
    s_setprio 0
    s_cmp_eq_u32 s57, 1
    s_cbranch_scc0 L_km_kernel_cb_11
    s_waitcnt vmcnt(8)
    s_barrier
L_km_kernel_cb_11:
    s_add_u32 m0, s68, 122880
    s_add_u32 s69, s64, 251904
    buffer_load_dwordx4 v1, s[28:31], s69 offen offset:0  lds
    v_exp_f32 v225, v225
    v_exp_f32 v226, v226
    v_exp_f32 v227, v227
    v_add_f32 v224, 1.0, v224
    v_add_f32 v225, 1.0, v225
    v_add_f32 v226, 1.0, v226
    v_add_f32 v227, 1.0, v227
    v_rcp_f32 v224, v224
    v_rcp_f32 v225, v225
    v_rcp_f32 v226, v226
    v_rcp_f32 v227, v227
    v_mul_f32 v224, v180, v224
    v_mul_f32 v225, v181, v225
    v_mul_f32 v226, v182, v226
    buffer_load_dwordx4 v1, s[28:31], s69 offen offset:1024  lds
    v_mul_f32 v227, v183, v227
    v_cvt_pk_bf16_f32 v230, v224, v225
    v_cvt_pk_bf16_f32 v231, v226, v227
    v_mul_f32 v212, v184, v184
    v_mul_f32 v213, v185, v185
    v_mul_f32 v214, v186, v186
    v_mul_f32 v215, v187, v187
    v_fma_f32 v212, v212, v3, v2
    v_fma_f32 v213, v213, v3, v2
    v_fma_f32 v214, v214, v3, v2
    v_fma_f32 v215, v215, v3, v2
    v_mul_f32 v216, v184, v212
    v_mul_f32 v217, v185, v213
    v_mul_f32 v218, v186, v214
    buffer_load_dwordx4 v1, s[28:31], s69 offen offset:2048  lds
    v_mul_f32 v219, v187, v215
    v_exp_f32 v216, v216
    v_exp_f32 v217, v217
    v_exp_f32 v218, v218
    v_exp_f32 v219, v219
    v_add_f32 v216, 1.0, v216
    v_add_f32 v217, 1.0, v217
    v_add_f32 v218, 1.0, v218
    v_add_f32 v219, 1.0, v219
    v_rcp_f32 v216, v216
    v_rcp_f32 v217, v217
    v_rcp_f32 v218, v218
    v_rcp_f32 v219, v219
    v_mul_f32 v216, v184, v216
    ds_read_b128 v[192:195], v12 offset:24576
    ds_read_b128 v[196:199], v12 offset:25600
    ds_read_b128 v[200:203], v12 offset:26624
    ds_read_b128 v[204:207], v12 offset:27648
    ds_read_b128 v[208:211], v12 offset:28672
    ds_read_b128 v[236:239], v12 offset:29696
    ds_read_b128 v[240:243], v12 offset:30720
    ds_read_b128 v[244:247], v12 offset:31744
    ds_read_b128 v[248:251], v12 offset:32768
    s_cmp_eq_u32 s57, 0
    s_cbranch_scc0 L_km_kernel_cb_12
    s_waitcnt vmcnt(11)
    s_barrier
L_km_kernel_cb_12:
    s_setprio 1
    s_waitcnt lgkmcnt(7)
    v_mfma_f32_32x32x16_bf16 v[160:175], v[192:195], v[64:67], v[160:175]
    ds_read_b128 v[192:195], v12 offset:33792
    v_mfma_f32_32x32x16_bf16 v[160:175], v[196:199], v[68:71], v[160:175]
    ds_read_b128 v[196:199], v12 offset:34816
    s_waitcnt lgkmcnt(7)
    v_mfma_f32_32x32x16_bf16 v[160:175], v[200:203], v[72:75], v[160:175]
    ds_read_b128 v[200:203], v12 offset:35840
    v_mfma_f32_32x32x16_bf16 v[160:175], v[204:207], v[76:79], v[160:175]
    s_waitcnt lgkmcnt(6)
    v_mfma_f32_32x32x16_bf16 v[160:175], v[208:211], v[80:83], v[160:175]
    v_mfma_f32_32x32x16_bf16 v[160:175], v[236:239], v[84:87], v[160:175]
    s_waitcnt lgkmcnt(4)
    v_mfma_f32_32x32x16_bf16 v[160:175], v[240:243], v[88:91], v[160:175]
    v_mfma_f32_32x32x16_bf16 v[160:175], v[244:247], v[92:95], v[160:175]
    s_waitcnt lgkmcnt(2)
    v_mfma_f32_32x32x16_bf16 v[160:175], v[248:251], v[96:99], v[160:175]
    v_mfma_f32_32x32x16_bf16 v[160:175], v[192:195], v[100:103], v[160:175]
    s_waitcnt lgkmcnt(0)
    v_mfma_f32_32x32x16_bf16 v[160:175], v[196:199], v[104:107], v[160:175]
    v_mfma_f32_32x32x16_bf16 v[160:175], v[200:203], v[108:111], v[160:175]
    s_setprio 0
    s_cmp_eq_u32 s57, 1
    s_cbranch_scc0 L_km_kernel_cb_13
    s_waitcnt vmcnt(8)
    s_barrier
L_km_kernel_cb_13:
    s_add_u32 m0, s68, 0
    s_add_u32 s69, s65, 0
    s_cmp_ge_u32 s52, 6
    s_cbranch_scc1 L_km_kernel_d8_14
    buffer_load_dwordx4 v1, s[28:31], s69 offen offset:0  lds
    buffer_load_dwordx4 v1, s[28:31], s69 offen offset:1024  lds
    buffer_load_dwordx4 v1, s[28:31], s69 offen offset:2048  lds
L_km_kernel_d8_14:
    v_mul_f32 v217, v185, v217
    v_mul_f32 v218, v186, v218
    v_mul_f32 v219, v187, v219
    v_cvt_pk_bf16_f32 v232, v216, v217
    v_cvt_pk_bf16_f32 v233, v218, v219
    v_mul_f32 v220, v188, v188
    v_mul_f32 v221, v189, v189
    v_mul_f32 v222, v190, v190
    v_mul_f32 v223, v191, v191
    v_fma_f32 v220, v220, v3, v2
    v_fma_f32 v221, v221, v3, v2
    v_fma_f32 v222, v222, v3, v2
    v_fma_f32 v223, v223, v3, v2
    v_mul_f32 v224, v188, v220
    v_mul_f32 v225, v189, v221
    v_mul_f32 v226, v190, v222
    v_mul_f32 v227, v191, v223
    v_exp_f32 v224, v224
    v_exp_f32 v225, v225
    v_exp_f32 v226, v226
    v_exp_f32 v227, v227
    v_add_f32 v224, 1.0, v224
    v_add_f32 v225, 1.0, v225
    v_add_f32 v226, 1.0, v226
    v_add_f32 v227, 1.0, v227
    v_rcp_f32 v224, v224
    v_rcp_f32 v225, v225
    v_rcp_f32 v226, v226
    v_rcp_f32 v227, v227
    v_mul_f32 v224, v188, v224
    v_mul_f32 v225, v189, v225
    v_mul_f32 v226, v190, v226
    v_mul_f32 v227, v191, v227
    v_cvt_pk_bf16_f32 v234, v224, v225
    v_cvt_pk_bf16_f32 v235, v226, v227
    s_add_u32 s71, s70, 4096
    v_permlane16_swap_b32 v228, v232
    v_permlane16_swap_b32 v229, v233
    v_permlane16_swap_b32 v230, v234
    v_permlane16_swap_b32 v231, v235
    buffer_store_dwordx4 v[228:231], v1, s[36:39], s71 offen offset:0 sc1
    buffer_store_dwordx4 v[232:235], v1, s[36:39], s71 offen offset:1024 sc1
    ds_read_b128 v[192:195], v13 offset:0
    ds_read_b128 v[196:199], v13 offset:1024
    ds_read_b128 v[200:203], v13 offset:2048
    ds_read_b128 v[204:207], v13 offset:3072
    ds_read_b128 v[208:211], v13 offset:4096
    ds_read_b128 v[236:239], v13 offset:5120
    ds_read_b128 v[240:243], v13 offset:6144
    ds_read_b128 v[244:247], v13 offset:7168
    ds_read_b128 v[248:251], v13 offset:8192
    s_cmp_eq_u32 s57, 0
    s_cbranch_scc0 L_km_kernel_cb_15
    s_waitcnt vmcnt(10)
    s_barrier
L_km_kernel_cb_15:
    s_setprio 1
    s_waitcnt lgkmcnt(7)
    v_mfma_f32_32x32x16_bf16 v[160:175], v[192:195], v[112:115], v[160:175]
    ds_read_b128 v[192:195], v13 offset:9216
    v_mfma_f32_32x32x16_bf16 v[160:175], v[196:199], v[116:119], v[160:175]
    ds_read_b128 v[196:199], v13 offset:10240
    s_waitcnt lgkmcnt(7)
    v_mfma_f32_32x32x16_bf16 v[160:175], v[200:203], v[120:123], v[160:175]
    ds_read_b128 v[200:203], v13 offset:11264
    v_mfma_f32_32x32x16_bf16 v[160:175], v[204:207], v[124:127], v[160:175]
    ds_read_b128 v[204:207], v15 offset:4096
    s_waitcnt lgkmcnt(7)
    v_mfma_f32_32x32x16_bf16 v[160:175], v[208:211], v[128:131], v[160:175]
    v_mfma_f32_32x32x16_bf16 v[160:175], v[236:239], v[132:135], v[160:175]
    s_waitcnt lgkmcnt(5)
    v_mfma_f32_32x32x16_bf16 v[160:175], v[240:243], v[136:139], v[160:175]
    v_mfma_f32_32x32x16_bf16 v[160:175], v[244:247], v[140:143], v[160:175]
    s_waitcnt lgkmcnt(3)
    v_mfma_f32_32x32x16_bf16 v[160:175], v[248:251], v[144:147], v[160:175]
    v_mfma_f32_32x32x16_bf16 v[160:175], v[192:195], v[148:151], v[160:175]
    s_waitcnt lgkmcnt(1)
    v_mfma_f32_32x32x16_bf16 v[160:175], v[196:199], v[152:155], v[160:175]
    v_mfma_f32_32x32x16_bf16 v[160:175], v[200:203], v[156:159], v[160:175]
    s_waitcnt lgkmcnt(0)
    v_mfma_f32_32x32x16_bf16 v[160:175], v[204:207], v[252:255], v[160:175]
    s_setprio 0
    s_cmp_eq_u32 s57, 1
    s_cbranch_scc0 L_km_kernel_cb_16
    s_waitcnt vmcnt(5)
    s_barrier
L_km_kernel_cb_16:
    s_add_u32 m0, s68, 24576
    s_add_u32 s69, s65, 18432
    s_cmp_ge_u32 s52, 6
    s_cbranch_scc1 L_km_kernel_d8_17
    buffer_load_dwordx4 v1, s[28:31], s69 offen offset:0  lds
    buffer_load_dwordx4 v1, s[28:31], s69 offen offset:1024  lds
    buffer_load_dwordx4 v1, s[28:31], s69 offen offset:2048  lds
L_km_kernel_d8_17:
    s_nop 4
    v_mul_f32 v212, v160, v160
    v_mul_f32 v213, v161, v161
    v_mul_f32 v214, v162, v162
    v_mul_f32 v215, v163, v163
    v_fma_f32 v212, v212, v3, v2
    v_fma_f32 v213, v213, v3, v2
    v_fma_f32 v214, v214, v3, v2
    v_fma_f32 v215, v215, v3, v2
    v_mul_f32 v216, v160, v212
    v_mul_f32 v217, v161, v213
    v_mul_f32 v218, v162, v214
    v_mul_f32 v219, v163, v215
    v_exp_f32 v216, v216
    v_exp_f32 v217, v217
    v_exp_f32 v218, v218
    v_exp_f32 v219, v219
    v_add_f32 v216, 1.0, v216
    v_add_f32 v217, 1.0, v217
    v_add_f32 v218, 1.0, v218
    v_add_f32 v219, 1.0, v219
    v_rcp_f32 v216, v216
    v_rcp_f32 v217, v217
    v_rcp_f32 v218, v218
    v_rcp_f32 v219, v219
    v_mul_f32 v216, v160, v216
    v_mul_f32 v217, v161, v217
    v_mul_f32 v218, v162, v218
    v_mul_f32 v219, v163, v219
    v_cvt_pk_bf16_f32 v228, v216, v217
    v_cvt_pk_bf16_f32 v229, v218, v219
    v_mul_f32 v220, v164, v164
    v_mul_f32 v221, v165, v165
    v_mul_f32 v222, v166, v166
    v_mul_f32 v223, v167, v167
    v_fma_f32 v220, v220, v3, v2
    v_fma_f32 v221, v221, v3, v2
    v_fma_f32 v222, v222, v3, v2
    v_fma_f32 v223, v223, v3, v2
    v_mul_f32 v224, v164, v220
    v_mul_f32 v225, v165, v221
    v_mul_f32 v226, v166, v222
    v_mul_f32 v227, v167, v223
    v_exp_f32 v224, v224
    ds_read_b128 v[192:195], v13 offset:24576
    ds_read_b128 v[196:199], v13 offset:25600
    ds_read_b128 v[200:203], v13 offset:26624
    ds_read_b128 v[204:207], v13 offset:27648
    ds_read_b128 v[208:211], v13 offset:28672
    ds_read_b128 v[236:239], v13 offset:29696
    ds_read_b128 v[240:243], v13 offset:30720
    ds_read_b128 v[244:247], v13 offset:31744
    ds_read_b128 v[248:251], v13 offset:32768
    s_cmp_eq_u32 s57, 0
    s_cbranch_scc0 L_km_kernel_cb_18
    s_waitcnt vmcnt(5)
    s_barrier
L_km_kernel_cb_18:
    s_setprio 1
    s_waitcnt lgkmcnt(7)
    v_mfma_f32_32x32x16_bf16 v[176:191], v[192:195], v[16:19], 0
    ds_read_b128 v[192:195], v13 offset:33792
    v_mfma_f32_32x32x16_bf16 v[176:191], v[196:199], v[20:23], v[176:191]
    ds_read_b128 v[196:199], v13 offset:34816
    s_waitcnt lgkmcnt(7)
    v_mfma_f32_32x32x16_bf16 v[176:191], v[200:203], v[24:27], v[176:191]
    ds_read_b128 v[200:203], v13 offset:35840
    v_mfma_f32_32x32x16_bf16 v[176:191], v[204:207], v[28:31], v[176:191]
    s_waitcnt lgkmcnt(6)
    v_mfma_f32_32x32x16_bf16 v[176:191], v[208:211], v[32:35], v[176:191]
    v_mfma_f32_32x32x16_bf16 v[176:191], v[236:239], v[36:39], v[176:191]
    s_waitcnt lgkmcnt(4)
    v_mfma_f32_32x32x16_bf16 v[176:191], v[240:243], v[40:43], v[176:191]
    v_mfma_f32_32x32x16_bf16 v[176:191], v[244:247], v[44:47], v[176:191]
    s_waitcnt lgkmcnt(2)
    v_mfma_f32_32x32x16_bf16 v[176:191], v[248:251], v[48:51], v[176:191]
    v_mfma_f32_32x32x16_bf16 v[176:191], v[192:195], v[52:55], v[176:191]
    s_waitcnt lgkmcnt(0)
    v_mfma_f32_32x32x16_bf16 v[176:191], v[196:199], v[56:59], v[176:191]
    v_mfma_f32_32x32x16_bf16 v[176:191], v[200:203], v[60:63], v[176:191]
    s_setprio 0
    s_cmp_eq_u32 s57, 1
    s_cbranch_scc0 L_km_kernel_cb_19
    s_waitcnt vmcnt(2)
    s_barrier
L_km_kernel_cb_19:
    s_add_u32 m0, s68, 49152
    s_add_u32 s69, s66, 0
    buffer_load_dwordx4 v1, s[32:35], s69 offen offset:0  lds
    v_exp_f32 v225, v225
    v_exp_f32 v226, v226
    v_exp_f32 v227, v227
    v_add_f32 v224, 1.0, v224
    v_add_f32 v225, 1.0, v225
    v_add_f32 v226, 1.0, v226
    v_add_f32 v227, 1.0, v227
    v_rcp_f32 v224, v224
    v_rcp_f32 v225, v225
    v_rcp_f32 v226, v226
    v_rcp_f32 v227, v227
    v_mul_f32 v224, v164, v224
    v_mul_f32 v225, v165, v225
    v_mul_f32 v226, v166, v226
    buffer_load_dwordx4 v1, s[32:35], s69 offen offset:1024  lds
    v_mul_f32 v227, v167, v227
    v_cvt_pk_bf16_f32 v230, v224, v225
    v_cvt_pk_bf16_f32 v231, v226, v227
    v_mul_f32 v212, v168, v168
    v_mul_f32 v213, v169, v169
    v_mul_f32 v214, v170, v170
    v_mul_f32 v215, v171, v171
    v_fma_f32 v212, v212, v3, v2
    v_fma_f32 v213, v213, v3, v2
    v_fma_f32 v214, v214, v3, v2
    v_fma_f32 v215, v215, v3, v2
    v_mul_f32 v216, v168, v212
    v_mul_f32 v217, v169, v213
    v_mul_f32 v218, v170, v214
    buffer_load_dwordx4 v1, s[32:35], s69 offen offset:2048  lds
    v_mul_f32 v219, v171, v215
    v_exp_f32 v216, v216
    v_exp_f32 v217, v217
    v_exp_f32 v218, v218
    v_exp_f32 v219, v219
    v_add_f32 v216, 1.0, v216
    v_add_f32 v217, 1.0, v217
    v_add_f32 v218, 1.0, v218
    v_add_f32 v219, 1.0, v219
    v_rcp_f32 v216, v216
    v_rcp_f32 v217, v217
    v_rcp_f32 v218, v218
    v_rcp_f32 v219, v219
    v_mul_f32 v216, v168, v216
    s_waitcnt vmcnt(3)
    v_mov_b32 v0, 2
    s_mov_b64 exec, 1
    buffer_store_dword v0, off, s[44:47], s74 sc1
    s_mov_b64 exec, -1
    ds_read_b128 v[192:195], v14 offset:0
    ds_read_b128 v[196:199], v14 offset:1024
    ds_read_b128 v[200:203], v14 offset:2048
    ds_read_b128 v[204:207], v14 offset:3072
    ds_read_b128 v[208:211], v14 offset:4096
    ds_read_b128 v[236:239], v14 offset:5120
    ds_read_b128 v[240:243], v14 offset:6144
    ds_read_b128 v[244:247], v14 offset:7168
    ds_read_b128 v[248:251], v14 offset:8192
    s_cmp_eq_u32 s57, 0
    s_cbranch_scc0 L_km_kernel_cb_21
    s_barrier
L_km_kernel_cb_21:
    s_setprio 1
    s_waitcnt lgkmcnt(7)
    v_mfma_f32_32x32x16_bf16 v[176:191], v[192:195], v[64:67], v[176:191]
    ds_read_b128 v[192:195], v14 offset:9216
    v_mfma_f32_32x32x16_bf16 v[176:191], v[196:199], v[68:71], v[176:191]
    ds_read_b128 v[196:199], v14 offset:10240
    s_waitcnt lgkmcnt(7)
    v_mfma_f32_32x32x16_bf16 v[176:191], v[200:203], v[72:75], v[176:191]
    ds_read_b128 v[200:203], v14 offset:11264
    v_mfma_f32_32x32x16_bf16 v[176:191], v[204:207], v[76:79], v[176:191]
    s_waitcnt lgkmcnt(6)
    v_mfma_f32_32x32x16_bf16 v[176:191], v[208:211], v[80:83], v[176:191]
    v_mfma_f32_32x32x16_bf16 v[176:191], v[236:239], v[84:87], v[176:191]
    s_waitcnt lgkmcnt(4)
    v_mfma_f32_32x32x16_bf16 v[176:191], v[240:243], v[88:91], v[176:191]
    v_mfma_f32_32x32x16_bf16 v[176:191], v[244:247], v[92:95], v[176:191]
    s_waitcnt lgkmcnt(2)
    v_mfma_f32_32x32x16_bf16 v[176:191], v[248:251], v[96:99], v[176:191]
    v_mfma_f32_32x32x16_bf16 v[176:191], v[192:195], v[100:103], v[176:191]
    s_waitcnt lgkmcnt(0)
    v_mfma_f32_32x32x16_bf16 v[176:191], v[196:199], v[104:107], v[176:191]
    v_mfma_f32_32x32x16_bf16 v[176:191], v[200:203], v[108:111], v[176:191]
    s_setprio 0
    s_cmp_eq_u32 s57, 1
    s_cbranch_scc0 L_km_kernel_cb_22
    s_barrier
L_km_kernel_cb_22:
    s_add_u32 m0, s68, 73728
    s_add_u32 s69, s66, 24576
    buffer_load_dwordx4 v1, s[32:35], s69 offen offset:0  lds
    v_mul_f32 v217, v169, v217
    v_mul_f32 v218, v170, v218
    v_mul_f32 v219, v171, v219
    v_cvt_pk_bf16_f32 v232, v216, v217
    v_cvt_pk_bf16_f32 v233, v218, v219
    v_mul_f32 v220, v172, v172
    v_mul_f32 v221, v173, v173
    v_mul_f32 v222, v174, v174
    v_mul_f32 v223, v175, v175
    v_fma_f32 v220, v220, v3, v2
    v_fma_f32 v221, v221, v3, v2
    v_fma_f32 v222, v222, v3, v2
    v_fma_f32 v223, v223, v3, v2
    v_mul_f32 v224, v172, v220
    buffer_load_dwordx4 v1, s[32:35], s69 offen offset:1024  lds
    v_mul_f32 v225, v173, v221
    v_mul_f32 v226, v174, v222
    v_mul_f32 v227, v175, v223
    v_exp_f32 v224, v224
    v_exp_f32 v225, v225
    v_exp_f32 v226, v226
    v_exp_f32 v227, v227
    v_add_f32 v224, 1.0, v224
    v_add_f32 v225, 1.0, v225
    v_add_f32 v226, 1.0, v226
    v_add_f32 v227, 1.0, v227
    v_rcp_f32 v224, v224
    v_rcp_f32 v225, v225
    v_rcp_f32 v226, v226
    buffer_load_dwordx4 v1, s[32:35], s69 offen offset:2048  lds
    v_rcp_f32 v227, v227
    v_mul_f32 v224, v172, v224
    v_mul_f32 v225, v173, v225
    v_mul_f32 v226, v174, v226
    v_mul_f32 v227, v175, v227
    v_cvt_pk_bf16_f32 v234, v224, v225
    v_cvt_pk_bf16_f32 v235, v226, v227
    s_add_u32 s71, s70, 8192
    v_permlane16_swap_b32 v228, v232
    v_permlane16_swap_b32 v229, v233
    v_permlane16_swap_b32 v230, v234
    v_permlane16_swap_b32 v231, v235
    buffer_store_dwordx4 v[228:231], v1, s[36:39], s71 offen offset:0 sc1
    buffer_store_dwordx4 v[232:235], v1, s[36:39], s71 offen offset:1024 sc1
    ds_read_b128 v[192:195], v14 offset:24576
    ds_read_b128 v[196:199], v14 offset:25600
    ds_read_b128 v[200:203], v14 offset:26624
    ds_read_b128 v[204:207], v14 offset:27648
    ds_read_b128 v[208:211], v14 offset:28672
    ds_read_b128 v[236:239], v14 offset:29696
    ds_read_b128 v[240:243], v14 offset:30720
    ds_read_b128 v[244:247], v14 offset:31744
    ds_read_b128 v[248:251], v14 offset:32768
    s_cmp_eq_u32 s57, 0
    s_cbranch_scc0 L_km_kernel_cb_23
    s_barrier
L_km_kernel_cb_23:
    s_setprio 1
    s_waitcnt lgkmcnt(7)
    v_mfma_f32_32x32x16_bf16 v[176:191], v[192:195], v[112:115], v[176:191]
    ds_read_b128 v[192:195], v14 offset:33792
    v_mfma_f32_32x32x16_bf16 v[176:191], v[196:199], v[116:119], v[176:191]
    ds_read_b128 v[196:199], v14 offset:34816
    s_waitcnt lgkmcnt(7)
    v_mfma_f32_32x32x16_bf16 v[176:191], v[200:203], v[120:123], v[176:191]
    ds_read_b128 v[200:203], v14 offset:35840
    v_mfma_f32_32x32x16_bf16 v[176:191], v[204:207], v[124:127], v[176:191]
    ds_read_b128 v[204:207], v15 offset:6144
    s_waitcnt lgkmcnt(7)
    v_mfma_f32_32x32x16_bf16 v[176:191], v[208:211], v[128:131], v[176:191]
    v_mfma_f32_32x32x16_bf16 v[176:191], v[236:239], v[132:135], v[176:191]
    s_waitcnt lgkmcnt(5)
    v_mfma_f32_32x32x16_bf16 v[176:191], v[240:243], v[136:139], v[176:191]
    v_mfma_f32_32x32x16_bf16 v[176:191], v[244:247], v[140:143], v[176:191]
    s_waitcnt lgkmcnt(3)
    v_mfma_f32_32x32x16_bf16 v[176:191], v[248:251], v[144:147], v[176:191]
    v_mfma_f32_32x32x16_bf16 v[176:191], v[192:195], v[148:151], v[176:191]
    s_waitcnt lgkmcnt(1)
    v_mfma_f32_32x32x16_bf16 v[176:191], v[196:199], v[152:155], v[176:191]
    v_mfma_f32_32x32x16_bf16 v[176:191], v[200:203], v[156:159], v[176:191]
    s_waitcnt lgkmcnt(0)
    v_mfma_f32_32x32x16_bf16 v[176:191], v[204:207], v[252:255], v[176:191]
    s_setprio 0
    s_cmp_eq_u32 s57, 1
    s_cbranch_scc0 L_km_kernel_cb_24
    s_barrier
L_km_kernel_cb_24:
    buffer_load_dword v5, v4, s[44:47], 0 offen sc1
    s_nop 7
    v_mul_f32 v212, v176, v176
    v_mul_f32 v213, v177, v177
    v_mul_f32 v214, v178, v178
    v_mul_f32 v215, v179, v179
    v_fma_f32 v212, v212, v3, v2
    v_fma_f32 v213, v213, v3, v2
    v_fma_f32 v214, v214, v3, v2
    v_fma_f32 v215, v215, v3, v2
    v_mul_f32 v216, v176, v212
    v_mul_f32 v217, v177, v213
    v_mul_f32 v218, v178, v214
    v_mul_f32 v219, v179, v215
    v_exp_f32 v216, v216
    v_exp_f32 v217, v217
    v_exp_f32 v218, v218
    v_exp_f32 v219, v219
    s_add_u32 m0, s68, 98304
    s_add_u32 s69, s66, 49152
    buffer_load_dwordx4 v1, s[32:35], s69 offen offset:0  lds
    v_add_f32 v216, 1.0, v216
    v_add_f32 v217, 1.0, v217
    v_add_f32 v218, 1.0, v218
    v_add_f32 v219, 1.0, v219
    v_rcp_f32 v216, v216
    v_rcp_f32 v217, v217
    v_rcp_f32 v218, v218
    v_rcp_f32 v219, v219
    v_mul_f32 v216, v176, v216
    v_mul_f32 v217, v177, v217
    v_mul_f32 v218, v178, v218
    v_mul_f32 v219, v179, v219
    v_cvt_pk_bf16_f32 v228, v216, v217
    v_cvt_pk_bf16_f32 v229, v218, v219
    v_mul_f32 v220, v180, v180
    v_mul_f32 v221, v181, v181
    buffer_load_dwordx4 v1, s[32:35], s69 offen offset:1024  lds
    v_mul_f32 v222, v182, v182
    v_mul_f32 v223, v183, v183
    v_fma_f32 v220, v220, v3, v2
    v_fma_f32 v221, v221, v3, v2
    v_fma_f32 v222, v222, v3, v2
    v_fma_f32 v223, v223, v3, v2
    v_mul_f32 v224, v180, v220
    v_mul_f32 v225, v181, v221
    v_mul_f32 v226, v182, v222
    v_mul_f32 v227, v183, v223
    v_exp_f32 v224, v224
    v_exp_f32 v225, v225
    v_exp_f32 v226, v226
    v_exp_f32 v227, v227
    v_add_f32 v224, 1.0, v224
    v_add_f32 v225, 1.0, v225
    buffer_load_dwordx4 v1, s[32:35], s69 offen offset:2048  lds
    v_add_f32 v226, 1.0, v226
    v_add_f32 v227, 1.0, v227
    v_rcp_f32 v224, v224
    v_rcp_f32 v225, v225
    v_rcp_f32 v226, v226
    v_rcp_f32 v227, v227
    v_mul_f32 v224, v180, v224
    v_mul_f32 v225, v181, v225
    v_mul_f32 v226, v182, v226
    v_mul_f32 v227, v183, v227
    v_cvt_pk_bf16_f32 v230, v224, v225
    v_cvt_pk_bf16_f32 v231, v226, v227
    v_mul_f32 v212, v184, v184
    v_mul_f32 v213, v185, v185
    v_mul_f32 v214, v186, v186
    v_mul_f32 v215, v187, v187
    s_cbranch_vccz L_km_kernel_gp_25
    ds_read_b128 v[192:195], v9 offset:0
    ds_read_b128 v[196:199], v9 offset:1024
    ds_read_b128 v[200:203], v9 offset:2048
    ds_read_b128 v[204:207], v9 offset:3072
    ds_read_b128 v[208:211], v9 offset:4096
    ds_read_b128 v[236:239], v9 offset:5120
    ds_read_b128 v[240:243], v9 offset:6144
    ds_read_b128 v[244:247], v9 offset:7168
    ds_read_b128 v[248:251], v9 offset:8192
L_km_kernel_gp_25:
    s_cmp_eq_u32 s57, 0
    s_cbranch_scc0 L_km_kernel_cb_26
    s_barrier
L_km_kernel_cb_26:
    s_setprio 1
    s_cbranch_vccz L_km_kernel_ga_27
    s_waitcnt lgkmcnt(7)
    v_mfma_f32_32x32x16_bf16 v[160:175], v[192:195], v[16:19], 0
    ds_read_b128 v[192:195], v9 offset:9216
    v_mfma_f32_32x32x16_bf16 v[160:175], v[196:199], v[20:23], v[160:175]
    ds_read_b128 v[196:199], v9 offset:10240
    s_waitcnt lgkmcnt(7)
    v_mfma_f32_32x32x16_bf16 v[160:175], v[200:203], v[24:27], v[160:175]
    ds_read_b128 v[200:203], v9 offset:11264
    v_mfma_f32_32x32x16_bf16 v[160:175], v[204:207], v[28:31], v[160:175]
    ds_read_b128 v[204:207], v9 offset:12288
    s_waitcnt lgkmcnt(7)
    v_mfma_f32_32x32x16_bf16 v[160:175], v[208:211], v[32:35], v[160:175]
    ds_read_b128 v[208:211], v9 offset:13312
    v_mfma_f32_32x32x16_bf16 v[160:175], v[236:239], v[36:39], v[160:175]
    ds_read_b128 v[236:239], v9 offset:14336
    s_waitcnt lgkmcnt(7)
    v_mfma_f32_32x32x16_bf16 v[160:175], v[240:243], v[40:43], v[160:175]
    ds_read_b128 v[240:243], v9 offset:15360
    v_mfma_f32_32x32x16_bf16 v[160:175], v[244:247], v[44:47], v[160:175]
    ds_read_b128 v[244:247], v9 offset:16384
    s_waitcnt lgkmcnt(7)
    v_mfma_f32_32x32x16_bf16 v[160:175], v[248:251], v[48:51], v[160:175]
    ds_read_b128 v[248:251], v9 offset:17408
    v_mfma_f32_32x32x16_bf16 v[160:175], v[192:195], v[52:55], v[160:175]
    s_waitcnt lgkmcnt(6)
    v_mfma_f32_32x32x16_bf16 v[160:175], v[196:199], v[56:59], v[160:175]
    v_mfma_f32_32x32x16_bf16 v[160:175], v[200:203], v[60:63], v[160:175]
    s_waitcnt lgkmcnt(4)
    v_mfma_f32_32x32x16_bf16 v[160:175], v[204:207], v[64:67], v[160:175]
    v_mfma_f32_32x32x16_bf16 v[160:175], v[208:211], v[68:71], v[160:175]
    s_waitcnt lgkmcnt(2)
    v_mfma_f32_32x32x16_bf16 v[160:175], v[236:239], v[72:75], v[160:175]
    v_mfma_f32_32x32x16_bf16 v[160:175], v[240:243], v[76:79], v[160:175]
    s_waitcnt lgkmcnt(0)
    v_mfma_f32_32x32x16_bf16 v[160:175], v[244:247], v[80:83], v[160:175]
    v_mfma_f32_32x32x16_bf16 v[160:175], v[248:251], v[84:87], v[160:175]
L_km_kernel_ga_27:
    s_setprio 0
    s_cmp_eq_u32 s57, 1
    s_cbranch_scc0 L_km_kernel_cb_28
    s_waitcnt vmcnt(10)
    s_barrier
L_km_kernel_cb_28:
    s_waitcnt vmcnt(3)
    v_cmp_gt_u32 s[76:77], 2, v5
    s_nop 0
    s_cmp_eq_u64 s[76:77], 0
    s_cbranch_scc1 L_km_kernel_ok_29
L_km_kernel_sp_30:
    s_sub_u32 s3, s3, 1
    s_cbranch_scc1 L_km_kernel_ok_29
    s_sleep 1
    buffer_load_dword v5, v4, s[44:47], 0 offen sc1
    s_waitcnt vmcnt(0)
    v_cmp_gt_u32 s[76:77], 2, v5
    s_nop 0
    s_cmp_eq_u64 s[76:77], 0
    s_cbranch_scc0 L_km_kernel_sp_30
L_km_kernel_ok_29:
    s_add_u32 s75, s72, 0
    buffer_load_dwordx4 v[16:19], v6, s[36:39], s75 offen sc1
    v_fma_f32 v212, v212, v3, v2
    v_fma_f32 v213, v213, v3, v2
    v_fma_f32 v214, v214, v3, v2
    v_fma_f32 v215, v215, v3, v2
    v_mul_f32 v216, v184, v212
    v_mul_f32 v217, v185, v213
    buffer_load_dwordx4 v[20:23], v7, s[36:39], s75 offen sc1
    v_mul_f32 v218, v186, v214
    v_mul_f32 v219, v187, v215
    v_exp_f32 v216, v216
    v_exp_f32 v217, v217
    v_exp_f32 v218, v218
    v_exp_f32 v219, v219
    s_add_u32 s75, s72, 18432
    buffer_load_dwordx4 v[24:27], v6, s[36:39], s75 offen sc1
    v_add_f32 v216, 1.0, v216
    v_add_f32 v217, 1.0, v217
    v_add_f32 v218, 1.0, v218
    v_add_f32 v219, 1.0, v219
    v_rcp_f32 v216, v216
    v_rcp_f32 v217, v217
    buffer_load_dwordx4 v[28:31], v7, s[36:39], s75 offen sc1
    v_rcp_f32 v218, v218
    v_rcp_f32 v219, v219
    v_mul_f32 v216, v184, v216
    v_mul_f32 v217, v185, v217
    v_mul_f32 v218, v186, v218
    v_mul_f32 v219, v187, v219
    s_add_u32 s75, s72, 36864
    buffer_load_dwordx4 v[32:35], v6, s[36:39], s75 offen sc1
    v_cvt_pk_bf16_f32 v232, v216, v217
    v_cvt_pk_bf16_f32 v233, v218, v219
    v_mul_f32 v220, v188, v188
    v_mul_f32 v221, v189, v189
    v_mul_f32 v222, v190, v190
    v_mul_f32 v223, v191, v191
    buffer_load_dwordx4 v[36:39], v7, s[36:39], s75 offen sc1
    v_fma_f32 v220, v220, v3, v2
    v_fma_f32 v221, v221, v3, v2
    v_fma_f32 v222, v222, v3, v2
    v_fma_f32 v223, v223, v3, v2
    v_mul_f32 v224, v188, v220
    v_mul_f32 v225, v189, v221
    s_add_u32 s75, s72, 55296
    buffer_load_dwordx4 v[40:43], v6, s[36:39], s75 offen sc1
    v_mul_f32 v226, v190, v222
    v_mul_f32 v227, v191, v223
    v_exp_f32 v224, v224
    v_exp_f32 v225, v225
    v_exp_f32 v226, v226
    v_exp_f32 v227, v227
    buffer_load_dwordx4 v[44:47], v7, s[36:39], s75 offen sc1
    v_add_f32 v224, 1.0, v224
    v_add_f32 v225, 1.0, v225
    v_add_f32 v226, 1.0, v226
    v_add_f32 v227, 1.0, v227
    v_rcp_f32 v224, v224
    v_rcp_f32 v225, v225
    s_add_u32 m0, s68, 122880
    s_add_u32 s69, s66, 73728
    buffer_load_dwordx4 v1, s[32:35], s69 offen offset:0  lds
    v_rcp_f32 v226, v226
    v_rcp_f32 v227, v227
    v_mul_f32 v224, v188, v224
    v_mul_f32 v225, v189, v225
    v_mul_f32 v226, v190, v226
    v_mul_f32 v227, v191, v227
    buffer_load_dwordx4 v1, s[32:35], s69 offen offset:1024  lds
    v_cvt_pk_bf16_f32 v234, v224, v225
    v_cvt_pk_bf16_f32 v235, v226, v227
    s_add_u32 s71, s70, 12288
    v_permlane16_swap_b32 v228, v232
    v_permlane16_swap_b32 v229, v233
    v_permlane16_swap_b32 v230, v234
    buffer_load_dwordx4 v1, s[32:35], s69 offen offset:2048  lds
    v_permlane16_swap_b32 v231, v235
    buffer_store_dwordx4 v[228:231], v1, s[36:39], s71 offen offset:0 sc1
    buffer_store_dwordx4 v[232:235], v1, s[36:39], s71 offen offset:1024 sc1
    v_mov_b32 v0, 3
    s_mov_b64 exec, 1
    buffer_store_dword v0, off, s[44:47], s74 sc1
    s_mov_b64 exec, -1
    s_cbranch_vccz L_km_kernel_gp_32
    ds_read_b128 v[192:195], v9 offset:24576
    ds_read_b128 v[196:199], v9 offset:25600
    ds_read_b128 v[200:203], v9 offset:26624
    ds_read_b128 v[204:207], v9 offset:27648
    ds_read_b128 v[208:211], v9 offset:28672
    ds_read_b128 v[236:239], v9 offset:29696
    ds_read_b128 v[240:243], v9 offset:30720
    ds_read_b128 v[244:247], v9 offset:31744
    ds_read_b128 v[248:251], v9 offset:32768
L_km_kernel_gp_32:
    s_cmp_eq_u32 s57, 0
    s_cbranch_scc0 L_km_kernel_cb_33
    s_barrier
L_km_kernel_cb_33:
    s_setprio 1
    s_cbranch_vccz L_km_kernel_ga_34
    s_waitcnt lgkmcnt(7)
    v_mfma_f32_32x32x16_bf16 v[160:175], v[192:195], v[88:91], v[160:175]
    ds_read_b128 v[192:195], v9 offset:33792
    v_mfma_f32_32x32x16_bf16 v[160:175], v[196:199], v[92:95], v[160:175]
    ds_read_b128 v[196:199], v9 offset:34816
    s_waitcnt lgkmcnt(7)
    v_mfma_f32_32x32x16_bf16 v[160:175], v[200:203], v[96:99], v[160:175]
    ds_read_b128 v[200:203], v9 offset:35840
    v_mfma_f32_32x32x16_bf16 v[160:175], v[204:207], v[100:103], v[160:175]
    ds_read_b128 v[204:207], v9 offset:36864
    s_waitcnt lgkmcnt(7)
    v_mfma_f32_32x32x16_bf16 v[160:175], v[208:211], v[104:107], v[160:175]
    ds_read_b128 v[208:211], v9 offset:37888
    v_mfma_f32_32x32x16_bf16 v[160:175], v[236:239], v[108:111], v[160:175]
    ds_read_b128 v[236:239], v9 offset:38912
    s_waitcnt lgkmcnt(7)
    v_mfma_f32_32x32x16_bf16 v[160:175], v[240:243], v[112:115], v[160:175]
    ds_read_b128 v[240:243], v9 offset:39936
    v_mfma_f32_32x32x16_bf16 v[160:175], v[244:247], v[116:119], v[160:175]
    ds_read_b128 v[244:247], v9 offset:40960
    s_waitcnt lgkmcnt(7)
    v_mfma_f32_32x32x16_bf16 v[160:175], v[248:251], v[120:123], v[160:175]
    ds_read_b128 v[248:251], v9 offset:41984
    v_mfma_f32_32x32x16_bf16 v[160:175], v[192:195], v[124:127], v[160:175]
    v_add_u32 v15, 147456, v1
    ds_read_b128 v[192:195], v15 offset:8192
    s_waitcnt lgkmcnt(7)
    v_mfma_f32_32x32x16_bf16 v[160:175], v[196:199], v[128:131], v[160:175]
    v_mfma_f32_32x32x16_bf16 v[160:175], v[200:203], v[132:135], v[160:175]
    s_waitcnt lgkmcnt(5)
    v_mfma_f32_32x32x16_bf16 v[160:175], v[204:207], v[136:139], v[160:175]
    v_mfma_f32_32x32x16_bf16 v[160:175], v[208:211], v[140:143], v[160:175]
    s_waitcnt lgkmcnt(3)
    v_mfma_f32_32x32x16_bf16 v[160:175], v[236:239], v[144:147], v[160:175]
    v_mfma_f32_32x32x16_bf16 v[160:175], v[240:243], v[148:151], v[160:175]
    s_waitcnt lgkmcnt(1)
    v_mfma_f32_32x32x16_bf16 v[160:175], v[244:247], v[152:155], v[160:175]
    v_mfma_f32_32x32x16_bf16 v[160:175], v[248:251], v[156:159], v[160:175]
    s_waitcnt lgkmcnt(0)
    v_mfma_f32_32x32x16_bf16 v[160:175], v[192:195], v[252:255], v[160:175]
L_km_kernel_ga_34:
    s_setprio 0
    s_cmp_eq_u32 s57, 1
    s_cbranch_scc0 L_km_kernel_cb_35
    s_barrier
L_km_kernel_cb_35:
    s_add_u32 s75, s72, 4096
    buffer_load_dwordx4 v[48:51], v6, s[36:39], s75 offen sc1
    buffer_load_dwordx4 v[52:55], v7, s[36:39], s75 offen sc1
    s_add_u32 s75, s72, 22528
    buffer_load_dwordx4 v[56:59], v6, s[36:39], s75 offen sc1
    buffer_load_dwordx4 v[60:63], v7, s[36:39], s75 offen sc1
    s_add_u32 m0, s68, 0
    s_add_u32 s69, s66, 98304
    buffer_load_dwordx4 v1, s[32:35], s69 offen offset:0  lds
    buffer_load_dwordx4 v1, s[32:35], s69 offen offset:1024  lds
    buffer_load_dwordx4 v1, s[32:35], s69 offen offset:2048  lds
    s_cbranch_vccz L_km_kernel_gf_36
    v_mul_f32 v112, v160, v160
    v_mul_f32 v113, v161, v161
    v_mul_f32 v114, v162, v162
    v_mul_f32 v115, v163, v163
    v_fma_f32 v112, v112, v3, v2
    v_fma_f32 v113, v113, v3, v2
    v_fma_f32 v114, v114, v3, v2
    v_fma_f32 v115, v115, v3, v2
    v_mul_f32 v116, v160, v112
    v_mul_f32 v117, v161, v113
    v_mul_f32 v118, v162, v114
    v_mul_f32 v119, v163, v115
    v_exp_f32 v116, v116
    v_exp_f32 v117, v117
    v_exp_f32 v118, v118
    v_exp_f32 v119, v119
    v_add_f32 v116, 1.0, v116
    v_add_f32 v117, 1.0, v117
    v_add_f32 v118, 1.0, v118
    v_add_f32 v119, 1.0, v119
    v_rcp_f32 v116, v116
    v_rcp_f32 v117, v117
    v_rcp_f32 v118, v118
    v_rcp_f32 v119, v119
    v_mul_f32 v116, v160, v116
    v_mul_f32 v117, v161, v117
    v_mul_f32 v118, v162, v118
    v_mul_f32 v119, v163, v119
    v_cvt_pk_bf16_f32 v128, v116, v117
    v_cvt_pk_bf16_f32 v129, v118, v119
    v_mul_f32 v120, v164, v164
    v_mul_f32 v121, v165, v165
    v_mul_f32 v122, v166, v166
    v_mul_f32 v123, v167, v167
    v_fma_f32 v120, v120, v3, v2
    v_fma_f32 v121, v121, v3, v2
    v_fma_f32 v122, v122, v3, v2
    v_fma_f32 v123, v123, v3, v2
    v_mul_f32 v124, v164, v120
    v_mul_f32 v125, v165, v121
    v_mul_f32 v126, v166, v122
    v_mul_f32 v127, v167, v123
    v_exp_f32 v124, v124
    v_exp_f32 v125, v125
    v_exp_f32 v126, v126
    v_exp_f32 v127, v127
    v_add_f32 v124, 1.0, v124
    v_add_f32 v125, 1.0, v125
    v_add_f32 v126, 1.0, v126
    v_add_f32 v127, 1.0, v127
    v_rcp_f32 v124, v124
    v_rcp_f32 v125, v125
    v_rcp_f32 v126, v126
    v_rcp_f32 v127, v127
    v_mul_f32 v124, v164, v124
    v_mul_f32 v125, v165, v125
    v_mul_f32 v126, v166, v126
    v_mul_f32 v127, v167, v127
    v_cvt_pk_bf16_f32 v130, v124, v125
    v_cvt_pk_bf16_f32 v131, v126, v127
    v_mul_f32 v112, v168, v168
    v_mul_f32 v113, v169, v169
    v_mul_f32 v114, v170, v170
    v_mul_f32 v115, v171, v171
    v_fma_f32 v112, v112, v3, v2
L_km_kernel_gf_36:
    ds_read_b128 v[192:195], v13 offset:0
    ds_read_b128 v[196:199], v13 offset:1024
    ds_read_b128 v[200:203], v13 offset:2048
    ds_read_b128 v[204:207], v13 offset:3072
    ds_read_b128 v[208:211], v13 offset:4096
    s_cmp_eq_u32 s57, 0
    s_cbranch_scc0 L_km_kernel_cb_37
    s_barrier
L_km_kernel_cb_37:
    s_setprio 1
    s_waitcnt lgkmcnt(3)
    s_waitcnt vmcnt(19)
    v_mfma_f32_16x16x32_bf16 v[176:179], v[192:195], v[16:19], 0
    v_mfma_f32_16x16x32_bf16 v[180:183], v[192:195], v[20:23], 0
    ds_read_b128 v[192:195], v13 offset:5120
    v_mfma_f32_16x16x32_bf16 v[184:187], v[196:199], v[16:19], 0
    v_mfma_f32_16x16x32_bf16 v[188:191], v[196:199], v[20:23], 0
    ds_read_b128 v[196:199], v13 offset:6144
    s_waitcnt lgkmcnt(3)
    v_mfma_f32_16x16x32_bf16 v[212:215], v[200:203], v[16:19], 0
    v_mfma_f32_16x16x32_bf16 v[216:219], v[200:203], v[20:23], 0
    ds_read_b128 v[200:203], v13 offset:7168
    v_mfma_f32_16x16x32_bf16 v[220:223], v[204:207], v[16:19], 0
    v_mfma_f32_16x16x32_bf16 v[224:227], v[204:207], v[20:23], 0
    ds_read_b128 v[204:207], v13 offset:8192
    s_waitcnt lgkmcnt(3)
    v_mfma_f32_16x16x32_bf16 v[228:231], v[208:211], v[16:19], 0
    v_mfma_f32_16x16x32_bf16 v[232:235], v[208:211], v[20:23], 0
    ds_read_b128 v[208:211], v13 offset:9216
    v_mfma_f32_16x16x32_bf16 v[236:239], v[192:195], v[16:19], 0
    v_mfma_f32_16x16x32_bf16 v[240:243], v[192:195], v[20:23], 0
    ds_read_b128 v[192:195], v13 offset:10240
    s_waitcnt lgkmcnt(3)
    v_mfma_f32_16x16x32_bf16 v[244:247], v[196:199], v[16:19], 0
    v_mfma_f32_16x16x32_bf16 v[248:251], v[196:199], v[20:23], 0
    ds_read_b128 v[196:199], v13 offset:11264
    s_waitcnt vmcnt(17)
    v_mfma_f32_16x16x32_bf16 v[176:179], v[200:203], v[24:27], v[176:179]
    v_mfma_f32_16x16x32_bf16 v[180:183], v[200:203], v[28:31], v[180:183]
    s_waitcnt lgkmcnt(2)
    v_mfma_f32_16x16x32_bf16 v[184:187], v[204:207], v[24:27], v[184:187]
    v_mfma_f32_16x16x32_bf16 v[188:191], v[204:207], v[28:31], v[188:191]
    v_mfma_f32_16x16x32_bf16 v[212:215], v[208:211], v[24:27], v[212:215]
    v_mfma_f32_16x16x32_bf16 v[216:219], v[208:211], v[28:31], v[216:219]
    s_waitcnt lgkmcnt(0)
    v_mfma_f32_16x16x32_bf16 v[220:223], v[192:195], v[24:27], v[220:223]
    v_mfma_f32_16x16x32_bf16 v[224:227], v[192:195], v[28:31], v[224:227]
    v_mfma_f32_16x16x32_bf16 v[228:231], v[196:199], v[24:27], v[228:231]
    v_mfma_f32_16x16x32_bf16 v[232:235], v[196:199], v[28:31], v[232:235]
    s_setprio 0
    s_cmp_eq_u32 s57, 1
    s_cbranch_scc0 L_km_kernel_cb_38
    s_barrier
L_km_kernel_cb_38:
    v_lshrrev_b32 v15, 4, v1
    v_mul_u32_u24 v15, 12, v15
    s_xor_b32 s59, s67, 4096
    v_add_u32 v10, s67, v1
    v_add_u32 v11, s59, v1
    v_add_u32 v8, 147456, v10
    v_add_u32 v9, 147456, v11
    v_add_u32 v10, 98304, v10
    v_add_u32 v11, 98304, v11
    buffer_load_dword v5, v4, s[44:47], 0 offen sc1
    s_add_u32 s75, s72, 40960
    buffer_load_dwordx4 v[64:67], v6, s[36:39], s75 offen sc1
    buffer_load_dwordx4 v[68:71], v7, s[36:39], s75 offen sc1
    s_add_u32 s75, s72, 59392
    buffer_load_dwordx4 v[72:75], v6, s[36:39], s75 offen sc1
    buffer_load_dwordx4 v[76:79], v7, s[36:39], s75 offen sc1
    s_add_u32 m0, s68, 24576
    s_add_u32 s69, s66, 122880
    buffer_load_dwordx4 v1, s[32:35], s69 offen offset:0  lds
    buffer_load_dwordx4 v1, s[32:35], s69 offen offset:1024  lds
    buffer_load_dwordx4 v1, s[32:35], s69 offen offset:2048  lds
    s_waitcnt vmcnt(16)
    v_mov_b32 v0, 4
    s_mov_b64 exec, 1
    buffer_store_dword v0, off, s[44:47], s74 sc1
    s_mov_b64 exec, -1
    s_cbranch_vccz L_km_kernel_gf_40
    v_fma_f32 v113, v113, v3, v2
    v_fma_f32 v114, v114, v3, v2
    v_fma_f32 v115, v115, v3, v2
    v_mul_f32 v116, v168, v112
    v_mul_f32 v117, v169, v113
    v_mul_f32 v118, v170, v114
    v_mul_f32 v119, v171, v115
    v_exp_f32 v116, v116
    v_exp_f32 v117, v117
    v_exp_f32 v118, v118
    v_exp_f32 v119, v119
    v_add_f32 v116, 1.0, v116
    v_add_f32 v117, 1.0, v117
    v_add_f32 v118, 1.0, v118
    v_add_f32 v119, 1.0, v119
    v_rcp_f32 v116, v116
    v_rcp_f32 v117, v117
    v_rcp_f32 v118, v118
    v_rcp_f32 v119, v119
    v_mul_f32 v116, v168, v116
    v_mul_f32 v117, v169, v117
    v_mul_f32 v118, v170, v118
    v_mul_f32 v119, v171, v119
    v_cvt_pk_bf16_f32 v132, v116, v117
    v_cvt_pk_bf16_f32 v133, v118, v119
    v_mul_f32 v120, v172, v172
    v_mul_f32 v121, v173, v173
    v_mul_f32 v122, v174, v174
    v_mul_f32 v123, v175, v175
    v_fma_f32 v120, v120, v3, v2
    v_fma_f32 v121, v121, v3, v2
    v_fma_f32 v122, v122, v3, v2
    v_fma_f32 v123, v123, v3, v2
    v_mul_f32 v124, v172, v120
    v_mul_f32 v125, v173, v121
    v_mul_f32 v126, v174, v122
    v_mul_f32 v127, v175, v123
    v_exp_f32 v124, v124
    v_exp_f32 v125, v125
    v_exp_f32 v126, v126
    v_exp_f32 v127, v127
    v_add_f32 v124, 1.0, v124
    v_add_f32 v125, 1.0, v125
    v_add_f32 v126, 1.0, v126
    v_add_f32 v127, 1.0, v127
    v_rcp_f32 v124, v124
    v_rcp_f32 v125, v125
    v_rcp_f32 v126, v126
    v_rcp_f32 v127, v127
    v_mul_f32 v124, v172, v124
    v_mul_f32 v125, v173, v125
    v_mul_f32 v126, v174, v126
    v_mul_f32 v127, v175, v127
    v_cvt_pk_bf16_f32 v134, v124, v125
    v_cvt_pk_bf16_f32 v135, v126, v127
    s_lshl_b32 s71, s57, 11
    s_sub_u32 s71, s70, s71
    s_add_u32 s71, s71, 16384
    v_permlane16_swap_b32 v128, v132
    v_permlane16_swap_b32 v129, v133
    v_permlane16_swap_b32 v130, v134
    v_permlane16_swap_b32 v131, v135
    buffer_store_dwordx4 v[128:131], v1, s[36:39], s71 offen offset:0 sc1
    buffer_store_dwordx4 v[132:135], v1, s[36:39], s71 offen offset:1024 sc1
L_km_kernel_gf_40:
    ds_read_b128 v[192:195], v13 offset:24576
    ds_read_b128 v[196:199], v13 offset:25600
    ds_read_b128 v[200:203], v13 offset:26624
    ds_read_b128 v[204:207], v13 offset:27648
    ds_read_b128 v[208:211], v13 offset:28672
    s_cmp_eq_u32 s57, 0
    s_cbranch_scc0 L_km_kernel_cb_41
    s_barrier
L_km_kernel_cb_41:
    s_setprio 1
    s_waitcnt lgkmcnt(3)
    v_mfma_f32_16x16x32_bf16 v[236:239], v[192:195], v[24:27], v[236:239]
    v_mfma_f32_16x16x32_bf16 v[240:243], v[192:195], v[28:31], v[240:243]
    ds_read_b128 v[192:195], v13 offset:29696
    v_mfma_f32_16x16x32_bf16 v[244:247], v[196:199], v[24:27], v[244:247]
    v_mfma_f32_16x16x32_bf16 v[248:251], v[196:199], v[28:31], v[248:251]
    ds_read_b128 v[196:199], v13 offset:30720
    s_waitcnt lgkmcnt(3)
    v_mfma_f32_16x16x32_bf16 v[176:179], v[200:203], v[32:35], v[176:179]
    v_mfma_f32_16x16x32_bf16 v[180:183], v[200:203], v[36:39], v[180:183]
    ds_read_b128 v[200:203], v13 offset:31744
    v_mfma_f32_16x16x32_bf16 v[184:187], v[204:207], v[32:35], v[184:187]
    v_mfma_f32_16x16x32_bf16 v[188:191], v[204:207], v[36:39], v[188:191]
    ds_read_b128 v[204:207], v13 offset:32768
    s_waitcnt lgkmcnt(3)
    v_mfma_f32_16x16x32_bf16 v[212:215], v[208:211], v[32:35], v[212:215]
    v_mfma_f32_16x16x32_bf16 v[216:219], v[208:211], v[36:39], v[216:219]
    ds_read_b128 v[208:211], v13 offset:33792
    v_mfma_f32_16x16x32_bf16 v[220:223], v[192:195], v[32:35], v[220:223]
    v_mfma_f32_16x16x32_bf16 v[224:227], v[192:195], v[36:39], v[224:227]
    ds_read_b128 v[192:195], v13 offset:34816
    s_waitcnt lgkmcnt(3)
    v_mfma_f32_16x16x32_bf16 v[228:231], v[196:199], v[32:35], v[228:231]
    v_mfma_f32_16x16x32_bf16 v[232:235], v[196:199], v[36:39], v[232:235]
    ds_read_b128 v[196:199], v13 offset:35840
    v_mfma_f32_16x16x32_bf16 v[236:239], v[200:203], v[32:35], v[236:239]
    v_mfma_f32_16x16x32_bf16 v[240:243], v[200:203], v[36:39], v[240:243]
    s_waitcnt lgkmcnt(2)
    v_mfma_f32_16x16x32_bf16 v[244:247], v[204:207], v[32:35], v[244:247]
    v_mfma_f32_16x16x32_bf16 v[248:251], v[204:207], v[36:39], v[248:251]
    v_mfma_f32_16x16x32_bf16 v[176:179], v[208:211], v[40:43], v[176:179]
    v_mfma_f32_16x16x32_bf16 v[180:183], v[208:211], v[44:47], v[180:183]
    s_waitcnt lgkmcnt(0)
    v_mfma_f32_16x16x32_bf16 v[184:187], v[192:195], v[40:43], v[184:187]
    v_mfma_f32_16x16x32_bf16 v[188:191], v[192:195], v[44:47], v[188:191]
    v_mfma_f32_16x16x32_bf16 v[212:215], v[196:199], v[40:43], v[212:215]
    v_mfma_f32_16x16x32_bf16 v[216:219], v[196:199], v[44:47], v[216:219]
    s_setprio 0
    s_cmp_eq_u32 s57, 1
    s_cbranch_scc0 L_km_kernel_cb_42
    s_barrier
L_km_kernel_cb_42:
    v_bfe_u32 v3, v1, 4, 1
    v_cmp_eq_u32 s[76:77], s57, v3
    v_mov_b32 v3, 4
    s_nop 0
    v_cndmask_b32 v3, v3, 5, s[76:77]
    s_waitcnt vmcnt(8)
    v_cmp_gt_u32 s[76:77], 3, v5
    s_nop 0
    s_cmp_eq_u64 s[76:77], 0
    s_cbranch_scc1 L_km_kernel_ok_43
L_km_kernel_sp_44:
    s_sub_u32 s3, s3, 1
    s_cbranch_scc1 L_km_kernel_ok_43
    s_sleep 1
    buffer_load_dword v5, v4, s[44:47], 0 offen sc1
    s_waitcnt vmcnt(0)
    v_cmp_gt_u32 s[76:77], 3, v5
    s_nop 0
    s_cmp_eq_u64 s[76:77], 0
    s_cbranch_scc0 L_km_kernel_sp_44
L_km_kernel_ok_43:
    s_add_u32 s75, s72, 8192
    buffer_load_dwordx4 v[80:83], v6, s[36:39], s75 offen sc1
    buffer_load_dwordx4 v[84:87], v7, s[36:39], s75 offen sc1
    s_add_u32 s75, s72, 26624
    buffer_load_dwordx4 v[88:91], v6, s[36:39], s75 offen sc1
    buffer_load_dwordx4 v[92:95], v7, s[36:39], s75 offen sc1
    s_add_u32 m0, s68, 49152
    s_add_u32 s69, s66, 147456
    buffer_load_dwordx4 v1, s[32:35], s69 offen offset:0  lds
    buffer_load_dwordx4 v1, s[32:35], s69 offen offset:1024  lds
    buffer_load_dwordx4 v1, s[32:35], s69 offen offset:2048  lds
    ds_read_b128 v[192:195], v14 offset:0
    ds_read_b128 v[196:199], v14 offset:1024
    ds_read_b128 v[200:203], v14 offset:2048
    ds_read_b128 v[204:207], v14 offset:3072
    ds_read_b128 v[208:211], v14 offset:4096
    ds_read_b128 v[160:163], v14 offset:5120
    ds_read_b128 v[164:167], v14 offset:6144
    ds_read_b128 v[168:171], v14 offset:7168
    ds_read_b128 v[172:175], v14 offset:8192
    s_cmp_eq_u32 s57, 0
    s_cbranch_scc0 L_km_kernel_cb_45
    s_barrier
L_km_kernel_cb_45:
    s_setprio 1
    s_waitcnt lgkmcnt(7)
    v_mfma_f32_16x16x32_bf16 v[220:223], v[192:195], v[40:43], v[220:223]
    v_mfma_f32_16x16x32_bf16 v[224:227], v[192:195], v[44:47], v[224:227]
    ds_read_b128 v[192:195], v14 offset:9216
    v_mfma_f32_16x16x32_bf16 v[228:231], v[196:199], v[40:43], v[228:231]
    v_mfma_f32_16x16x32_bf16 v[232:235], v[196:199], v[44:47], v[232:235]
    ds_read_b128 v[196:199], v14 offset:10240
    s_waitcnt lgkmcnt(7)
    v_mfma_f32_16x16x32_bf16 v[236:239], v[200:203], v[40:43], v[236:239]
    v_mfma_f32_16x16x32_bf16 v[240:243], v[200:203], v[44:47], v[240:243]
    ds_read_b128 v[200:203], v14 offset:11264
    v_mfma_f32_16x16x32_bf16 v[244:247], v[204:207], v[40:43], v[244:247]
    v_mfma_f32_16x16x32_bf16 v[248:251], v[204:207], v[44:47], v[248:251]
    s_waitcnt lgkmcnt(6)
    v_mfma_f32_16x16x32_bf16 v[176:179], v[208:211], v[48:51], v[176:179]
    v_mfma_f32_16x16x32_bf16 v[180:183], v[208:211], v[52:55], v[180:183]
    v_mfma_f32_16x16x32_bf16 v[184:187], v[160:163], v[48:51], v[184:187]
    v_mfma_f32_16x16x32_bf16 v[188:191], v[160:163], v[52:55], v[188:191]
    s_waitcnt lgkmcnt(4)
    v_mfma_f32_16x16x32_bf16 v[212:215], v[164:167], v[48:51], v[212:215]
    v_mfma_f32_16x16x32_bf16 v[216:219], v[164:167], v[52:55], v[216:219]
    v_mfma_f32_16x16x32_bf16 v[220:223], v[168:171], v[48:51], v[220:223]
    v_mfma_f32_16x16x32_bf16 v[224:227], v[168:171], v[52:55], v[224:227]
    s_waitcnt lgkmcnt(2)
    v_mfma_f32_16x16x32_bf16 v[228:231], v[172:175], v[48:51], v[228:231]
    v_mfma_f32_16x16x32_bf16 v[232:235], v[172:175], v[52:55], v[232:235]
    v_mfma_f32_16x16x32_bf16 v[236:239], v[192:195], v[48:51], v[236:239]
    v_mfma_f32_16x16x32_bf16 v[240:243], v[192:195], v[52:55], v[240:243]
    s_waitcnt lgkmcnt(0)
    v_mfma_f32_16x16x32_bf16 v[244:247], v[196:199], v[48:51], v[244:247]
    v_mfma_f32_16x16x32_bf16 v[248:251], v[196:199], v[52:55], v[248:251]
    v_mfma_f32_16x16x32_bf16 v[176:179], v[200:203], v[56:59], v[176:179]
    v_mfma_f32_16x16x32_bf16 v[180:183], v[200:203], v[60:63], v[180:183]
    s_setprio 0
    s_cmp_eq_u32 s57, 1
    s_cbranch_scc0 L_km_kernel_cb_46
    s_barrier
L_km_kernel_cb_46:
    buffer_load_dword v5, v4, s[44:47], 0 offen sc1
    s_add_u32 s75, s72, 45056
    buffer_load_dwordx4 v[96:99], v6, s[36:39], s75 offen sc1
    buffer_load_dwordx4 v[100:103], v7, s[36:39], s75 offen sc1
    s_add_u32 s75, s72, 63488
    buffer_load_dwordx4 v[104:107], v6, s[36:39], s75 offen sc1
    buffer_load_dwordx4 v[108:111], v7, s[36:39], s75 offen sc1
    s_add_u32 m0, s68, 73728
    s_add_u32 s69, s66, 172032
    buffer_load_dwordx4 v1, s[32:35], s69 offen offset:0  lds
    buffer_load_dwordx4 v1, s[32:35], s69 offen offset:1024  lds
    buffer_load_dwordx4 v1, s[32:35], s69 offen offset:2048  lds
    s_waitcnt vmcnt(15)
    s_cbranch_vccz L_km_kernel_fs_47
    v_mov_b32 v0, 5
    s_mov_b64 exec, 1
    buffer_store_dword v0, off, s[44:47], s74 sc1
    s_mov_b64 exec, -1
L_km_kernel_fs_47:
    ds_read_b128 v[192:195], v14 offset:24576
    ds_read_b128 v[196:199], v14 offset:25600
    ds_read_b128 v[200:203], v14 offset:26624
    ds_read_b128 v[204:207], v14 offset:27648
    ds_read_b128 v[208:211], v14 offset:28672
    ds_read_b128 v[160:163], v14 offset:29696
    ds_read_b128 v[164:167], v14 offset:30720
    ds_read_b128 v[168:171], v14 offset:31744
    ds_read_b128 v[172:175], v14 offset:32768
    s_cmp_eq_u32 s57, 0
    s_cbranch_scc0 L_km_kernel_cb_48
    s_barrier
L_km_kernel_cb_48:
    s_setprio 1
    s_waitcnt lgkmcnt(7)
    v_mfma_f32_16x16x32_bf16 v[184:187], v[192:195], v[56:59], v[184:187]
    v_mfma_f32_16x16x32_bf16 v[188:191], v[192:195], v[60:63], v[188:191]
    ds_read_b128 v[192:195], v14 offset:33792
    v_mfma_f32_16x16x32_bf16 v[212:215], v[196:199], v[56:59], v[212:215]
    v_mfma_f32_16x16x32_bf16 v[216:219], v[196:199], v[60:63], v[216:219]
    ds_read_b128 v[196:199], v14 offset:34816
    s_waitcnt lgkmcnt(7)
    v_mfma_f32_16x16x32_bf16 v[220:223], v[200:203], v[56:59], v[220:223]
    v_mfma_f32_16x16x32_bf16 v[224:227], v[200:203], v[60:63], v[224:227]
    ds_read_b128 v[200:203], v14 offset:35840
    v_mfma_f32_16x16x32_bf16 v[228:231], v[204:207], v[56:59], v[228:231]
    v_mfma_f32_16x16x32_bf16 v[232:235], v[204:207], v[60:63], v[232:235]
    s_waitcnt lgkmcnt(6)
    v_mfma_f32_16x16x32_bf16 v[236:239], v[208:211], v[56:59], v[236:239]
    v_mfma_f32_16x16x32_bf16 v[240:243], v[208:211], v[60:63], v[240:243]
    v_mfma_f32_16x16x32_bf16 v[244:247], v[160:163], v[56:59], v[244:247]
    v_mfma_f32_16x16x32_bf16 v[248:251], v[160:163], v[60:63], v[248:251]
    s_waitcnt lgkmcnt(4)
    v_mfma_f32_16x16x32_bf16 v[176:179], v[164:167], v[64:67], v[176:179]
    v_mfma_f32_16x16x32_bf16 v[180:183], v[164:167], v[68:71], v[180:183]
    v_mfma_f32_16x16x32_bf16 v[184:187], v[168:171], v[64:67], v[184:187]
    v_mfma_f32_16x16x32_bf16 v[188:191], v[168:171], v[68:71], v[188:191]
    s_waitcnt lgkmcnt(2)
    v_mfma_f32_16x16x32_bf16 v[212:215], v[172:175], v[64:67], v[212:215]
    v_mfma_f32_16x16x32_bf16 v[216:219], v[172:175], v[68:71], v[216:219]
    v_mfma_f32_16x16x32_bf16 v[220:223], v[192:195], v[64:67], v[220:223]
    v_mfma_f32_16x16x32_bf16 v[224:227], v[192:195], v[68:71], v[224:227]
    s_waitcnt lgkmcnt(0)
    v_mfma_f32_16x16x32_bf16 v[228:231], v[196:199], v[64:67], v[228:231]
    v_mfma_f32_16x16x32_bf16 v[232:235], v[196:199], v[68:71], v[232:235]
    v_mfma_f32_16x16x32_bf16 v[236:239], v[200:203], v[64:67], v[236:239]
    v_mfma_f32_16x16x32_bf16 v[240:243], v[200:203], v[68:71], v[240:243]
    s_setprio 0
    s_cmp_eq_u32 s57, 1
    s_cbranch_scc0 L_km_kernel_cb_49
    s_barrier
L_km_kernel_cb_49:
    s_waitcnt vmcnt(7)
    v_cmp_gt_u32 s[76:77], 4, v5
    s_nop 0
    s_cmp_eq_u64 s[76:77], 0
    s_cbranch_scc1 L_km_kernel_ok_50
L_km_kernel_sp_51:
    s_sub_u32 s3, s3, 1
    s_cbranch_scc1 L_km_kernel_ok_50
    s_sleep 1
    buffer_load_dword v5, v4, s[44:47], 0 offen sc1
    s_waitcnt vmcnt(0)
    v_cmp_gt_u32 s[76:77], 4, v5
    s_nop 0
    s_cmp_eq_u64 s[76:77], 0
    s_cbranch_scc0 L_km_kernel_sp_51
L_km_kernel_ok_50:
    s_add_u32 s75, s72, 12288
    buffer_load_dwordx4 v[112:115], v6, s[36:39], s75 offen sc1
    buffer_load_dwordx4 v[116:119], v7, s[36:39], s75 offen sc1
    s_add_u32 s75, s72, 30720
    buffer_load_dwordx4 v[120:123], v6, s[36:39], s75 offen sc1
    buffer_load_dwordx4 v[124:127], v7, s[36:39], s75 offen sc1
    s_add_u32 m0, s68, 98304
    s_add_u32 s69, s66, 196608
    buffer_load_dwordx4 v1, s[32:35], s69 offen offset:0  lds
    buffer_load_dwordx4 v1, s[32:35], s69 offen offset:1024  lds
    buffer_load_dwordx4 v1, s[32:35], s69 offen offset:2048  lds
    ds_read_b128 v[192:195], v12 offset:0
    ds_read_b128 v[196:199], v12 offset:1024
    ds_read_b128 v[200:203], v12 offset:2048
    ds_read_b128 v[204:207], v12 offset:3072
    ds_read_b128 v[208:211], v12 offset:4096
    ds_read_b128 v[160:163], v12 offset:5120
    ds_read_b128 v[164:167], v12 offset:6144
    ds_read_b128 v[168:171], v12 offset:7168
    ds_read_b128 v[172:175], v12 offset:8192
    s_cmp_eq_u32 s57, 0
    s_cbranch_scc0 L_km_kernel_cb_52
    s_barrier
L_km_kernel_cb_52:
    s_setprio 1
    s_waitcnt lgkmcnt(7)
    v_mfma_f32_16x16x32_bf16 v[244:247], v[192:195], v[64:67], v[244:247]
    v_mfma_f32_16x16x32_bf16 v[248:251], v[192:195], v[68:71], v[248:251]
    ds_read_b128 v[192:195], v12 offset:9216
    v_mfma_f32_16x16x32_bf16 v[176:179], v[196:199], v[72:75], v[176:179]
    v_mfma_f32_16x16x32_bf16 v[180:183], v[196:199], v[76:79], v[180:183]
    ds_read_b128 v[196:199], v12 offset:10240
    s_waitcnt lgkmcnt(7)
    v_mfma_f32_16x16x32_bf16 v[184:187], v[200:203], v[72:75], v[184:187]
    v_mfma_f32_16x16x32_bf16 v[188:191], v[200:203], v[76:79], v[188:191]
    ds_read_b128 v[200:203], v12 offset:11264
    v_mfma_f32_16x16x32_bf16 v[212:215], v[204:207], v[72:75], v[212:215]
    v_mfma_f32_16x16x32_bf16 v[216:219], v[204:207], v[76:79], v[216:219]
    s_waitcnt lgkmcnt(6)
    v_mfma_f32_16x16x32_bf16 v[220:223], v[208:211], v[72:75], v[220:223]
    v_mfma_f32_16x16x32_bf16 v[224:227], v[208:211], v[76:79], v[224:227]
    v_mfma_f32_16x16x32_bf16 v[228:231], v[160:163], v[72:75], v[228:231]
    v_mfma_f32_16x16x32_bf16 v[232:235], v[160:163], v[76:79], v[232:235]
    s_waitcnt lgkmcnt(4)
    v_mfma_f32_16x16x32_bf16 v[236:239], v[164:167], v[72:75], v[236:239]
    v_mfma_f32_16x16x32_bf16 v[240:243], v[164:167], v[76:79], v[240:243]
    v_mfma_f32_16x16x32_bf16 v[244:247], v[168:171], v[72:75], v[244:247]
    v_mfma_f32_16x16x32_bf16 v[248:251], v[168:171], v[76:79], v[248:251]
    s_waitcnt lgkmcnt(2)
    v_mfma_f32_16x16x32_bf16 v[176:179], v[172:175], v[80:83], v[176:179]
    v_mfma_f32_16x16x32_bf16 v[180:183], v[172:175], v[84:87], v[180:183]
    v_mfma_f32_16x16x32_bf16 v[184:187], v[192:195], v[80:83], v[184:187]
    v_mfma_f32_16x16x32_bf16 v[188:191], v[192:195], v[84:87], v[188:191]
    s_waitcnt lgkmcnt(0)
    v_mfma_f32_16x16x32_bf16 v[212:215], v[196:199], v[80:83], v[212:215]
    v_mfma_f32_16x16x32_bf16 v[216:219], v[196:199], v[84:87], v[216:219]
    v_mfma_f32_16x16x32_bf16 v[220:223], v[200:203], v[80:83], v[220:223]
    v_mfma_f32_16x16x32_bf16 v[224:227], v[200:203], v[84:87], v[224:227]
    s_setprio 0
    s_cmp_eq_u32 s57, 1
    s_cbranch_scc0 L_km_kernel_cb_53
    s_barrier
L_km_kernel_cb_53:
    buffer_load_dword v5, v4, s[44:47], 0 offen sc1
    s_add_u32 s75, s72, 49152
    buffer_load_dwordx4 v[128:131], v6, s[36:39], s75 offen sc1
    buffer_load_dwordx4 v[132:135], v7, s[36:39], s75 offen sc1
    s_add_u32 s75, s72, 67584
    buffer_load_dwordx4 v[136:139], v6, s[36:39], s75 offen sc1
    buffer_load_dwordx4 v[140:143], v7, s[36:39], s75 offen sc1
    s_add_u32 m0, s68, 122880
    s_add_u32 s69, s66, 221184
    buffer_load_dwordx4 v1, s[32:35], s69 offen offset:0  lds
    buffer_load_dwordx4 v1, s[32:35], s69 offen offset:1024  lds
    buffer_load_dwordx4 v1, s[32:35], s69 offen offset:2048  lds
    ds_read_b128 v[192:195], v12 offset:24576
    ds_read_b128 v[196:199], v12 offset:25600
    ds_read_b128 v[200:203], v12 offset:26624
    ds_read_b128 v[204:207], v12 offset:27648
    ds_read_b128 v[208:211], v12 offset:28672
    ds_read_b128 v[160:163], v12 offset:29696
    ds_read_b128 v[164:167], v12 offset:30720
    ds_read_b128 v[168:171], v12 offset:31744
    ds_read_b128 v[172:175], v12 offset:32768
    s_cmp_eq_u32 s57, 0
    s_cbranch_scc0 L_km_kernel_cb_54
    s_barrier
L_km_kernel_cb_54:
    s_setprio 1
    s_waitcnt lgkmcnt(7)
    v_mfma_f32_16x16x32_bf16 v[228:231], v[192:195], v[80:83], v[228:231]
    v_mfma_f32_16x16x32_bf16 v[232:235], v[192:195], v[84:87], v[232:235]
    ds_read_b128 v[192:195], v12 offset:33792
    v_mfma_f32_16x16x32_bf16 v[236:239], v[196:199], v[80:83], v[236:239]
    v_mfma_f32_16x16x32_bf16 v[240:243], v[196:199], v[84:87], v[240:243]
    ds_read_b128 v[196:199], v12 offset:34816
    s_waitcnt lgkmcnt(7)
    v_mfma_f32_16x16x32_bf16 v[244:247], v[200:203], v[80:83], v[244:247]
    v_mfma_f32_16x16x32_bf16 v[248:251], v[200:203], v[84:87], v[248:251]
    ds_read_b128 v[200:203], v12 offset:35840
    v_mfma_f32_16x16x32_bf16 v[176:179], v[204:207], v[88:91], v[176:179]
    v_mfma_f32_16x16x32_bf16 v[180:183], v[204:207], v[92:95], v[180:183]
    s_waitcnt lgkmcnt(6)
    v_mfma_f32_16x16x32_bf16 v[184:187], v[208:211], v[88:91], v[184:187]
    v_mfma_f32_16x16x32_bf16 v[188:191], v[208:211], v[92:95], v[188:191]
    v_mfma_f32_16x16x32_bf16 v[212:215], v[160:163], v[88:91], v[212:215]
    v_mfma_f32_16x16x32_bf16 v[216:219], v[160:163], v[92:95], v[216:219]
    s_waitcnt lgkmcnt(4)
    v_mfma_f32_16x16x32_bf16 v[220:223], v[164:167], v[88:91], v[220:223]
    v_mfma_f32_16x16x32_bf16 v[224:227], v[164:167], v[92:95], v[224:227]
    v_mfma_f32_16x16x32_bf16 v[228:231], v[168:171], v[88:91], v[228:231]
    v_mfma_f32_16x16x32_bf16 v[232:235], v[168:171], v[92:95], v[232:235]
    s_waitcnt lgkmcnt(2)
    v_mfma_f32_16x16x32_bf16 v[236:239], v[172:175], v[88:91], v[236:239]
    v_mfma_f32_16x16x32_bf16 v[240:243], v[172:175], v[92:95], v[240:243]
    v_mfma_f32_16x16x32_bf16 v[244:247], v[192:195], v[88:91], v[244:247]
    v_mfma_f32_16x16x32_bf16 v[248:251], v[192:195], v[92:95], v[248:251]
    s_waitcnt lgkmcnt(0)
    s_waitcnt vmcnt(20)
    v_mfma_f32_16x16x32_bf16 v[176:179], v[196:199], v[96:99], v[176:179]
    v_mfma_f32_16x16x32_bf16 v[180:183], v[196:199], v[100:103], v[180:183]
    v_mfma_f32_16x16x32_bf16 v[184:187], v[200:203], v[96:99], v[184:187]
    v_mfma_f32_16x16x32_bf16 v[188:191], v[200:203], v[100:103], v[188:191]
    s_setprio 0
    s_cmp_eq_u32 s57, 1
    s_cbranch_scc0 L_km_kernel_cb_55
    s_waitcnt vmcnt(15)
    s_barrier
L_km_kernel_cb_55:
    s_waitcnt vmcnt(7)
    v_cmp_gt_u32 s[76:77], v3, v5
    s_nop 0
    s_cmp_eq_u64 s[76:77], 0
    s_cbranch_scc1 L_km_kernel_ok_56
L_km_kernel_sp_57:
    s_sub_u32 s3, s3, 1
    s_cbranch_scc1 L_km_kernel_ok_56
    s_sleep 1
    buffer_load_dword v5, v4, s[44:47], 0 offen sc1
    s_waitcnt vmcnt(0)
    v_cmp_gt_u32 s[76:77], v3, v5
    s_nop 0
    s_cmp_eq_u64 s[76:77], 0
    s_cbranch_scc0 L_km_kernel_sp_57
L_km_kernel_ok_56:
    s_add_u32 s75, s73, 0
    buffer_load_dwordx4 v[144:147], v6, s[36:39], s75 offen sc1
    buffer_load_dwordx4 v[148:151], v7, s[36:39], s75 offen sc1
    s_add_u32 s75, s73, 36864
    buffer_load_dwordx4 v[152:155], v6, s[36:39], s75 offen sc1
    buffer_load_dwordx4 v[156:159], v7, s[36:39], s75 offen sc1
    s_add_u32 m0, s68, 0
    s_add_u32 s69, s66, 245760
    buffer_load_dwordx4 v1, s[32:35], s69 offen offset:0  lds
    buffer_load_dwordx4 v1, s[32:35], s69 offen offset:1024  lds
    buffer_load_dwordx4 v1, s[32:35], s69 offen offset:2048  lds
    ds_read_b128 v[192:195], v13 offset:0
    ds_read_b128 v[196:199], v13 offset:1024
    ds_read_b128 v[200:203], v13 offset:2048
    ds_read_b128 v[204:207], v13 offset:3072
    ds_read_b128 v[208:211], v13 offset:4096
    ds_read_b128 v[160:163], v13 offset:5120
    ds_read_b128 v[164:167], v13 offset:6144
    ds_read_b128 v[168:171], v13 offset:7168
    ds_read_b128 v[172:175], v13 offset:8192
    s_cmp_eq_u32 s57, 0
    s_cbranch_scc0 L_km_kernel_cb_58
    s_barrier
L_km_kernel_cb_58:
    s_setprio 1
    s_waitcnt lgkmcnt(7)
    v_mfma_f32_16x16x32_bf16 v[212:215], v[192:195], v[96:99], v[212:215]
    v_mfma_f32_16x16x32_bf16 v[216:219], v[192:195], v[100:103], v[216:219]
    ds_read_b128 v[192:195], v13 offset:9216
    v_mfma_f32_16x16x32_bf16 v[220:223], v[196:199], v[96:99], v[220:223]
    v_mfma_f32_16x16x32_bf16 v[224:227], v[196:199], v[100:103], v[224:227]
    ds_read_b128 v[196:199], v13 offset:10240
    s_waitcnt lgkmcnt(7)
    v_mfma_f32_16x16x32_bf16 v[228:231], v[200:203], v[96:99], v[228:231]
    v_mfma_f32_16x16x32_bf16 v[232:235], v[200:203], v[100:103], v[232:235]
    ds_read_b128 v[200:203], v13 offset:11264
    v_mfma_f32_16x16x32_bf16 v[236:239], v[204:207], v[96:99], v[236:239]
    v_mfma_f32_16x16x32_bf16 v[240:243], v[204:207], v[100:103], v[240:243]
    s_waitcnt lgkmcnt(6)
    v_mfma_f32_16x16x32_bf16 v[244:247], v[208:211], v[96:99], v[244:247]
    v_mfma_f32_16x16x32_bf16 v[248:251], v[208:211], v[100:103], v[248:251]
    v_mfma_f32_16x16x32_bf16 v[176:179], v[160:163], v[104:107], v[176:179]
    v_mfma_f32_16x16x32_bf16 v[180:183], v[160:163], v[108:111], v[180:183]
    s_waitcnt lgkmcnt(4)
    v_mfma_f32_16x16x32_bf16 v[184:187], v[164:167], v[104:107], v[184:187]
    v_mfma_f32_16x16x32_bf16 v[188:191], v[164:167], v[108:111], v[188:191]
    v_mfma_f32_16x16x32_bf16 v[212:215], v[168:171], v[104:107], v[212:215]
    v_mfma_f32_16x16x32_bf16 v[216:219], v[168:171], v[108:111], v[216:219]
    s_waitcnt lgkmcnt(2)
    v_mfma_f32_16x16x32_bf16 v[220:223], v[172:175], v[104:107], v[220:223]
    v_mfma_f32_16x16x32_bf16 v[224:227], v[172:175], v[108:111], v[224:227]
    v_mfma_f32_16x16x32_bf16 v[228:231], v[192:195], v[104:107], v[228:231]
    v_mfma_f32_16x16x32_bf16 v[232:235], v[192:195], v[108:111], v[232:235]
    s_waitcnt lgkmcnt(0)
    v_mfma_f32_16x16x32_bf16 v[236:239], v[196:199], v[104:107], v[236:239]
    v_mfma_f32_16x16x32_bf16 v[240:243], v[196:199], v[108:111], v[240:243]
    v_mfma_f32_16x16x32_bf16 v[244:247], v[200:203], v[104:107], v[244:247]
    v_mfma_f32_16x16x32_bf16 v[248:251], v[200:203], v[108:111], v[248:251]
    s_setprio 0
    s_cmp_eq_u32 s57, 1
    s_cbranch_scc0 L_km_kernel_cb_59
    s_barrier
L_km_kernel_cb_59:
    s_add_u32 m0, s68, 24576
    s_add_u32 s69, s66, 270336
    buffer_load_dwordx4 v1, s[32:35], s69 offen offset:0  lds
    buffer_load_dwordx4 v1, s[32:35], s69 offen offset:1024  lds
    buffer_load_dwordx4 v1, s[32:35], s69 offen offset:2048  lds
    ds_read_b128 v[192:195], v13 offset:24576
    ds_read_b128 v[196:199], v13 offset:25600
    ds_read_b128 v[200:203], v13 offset:26624
    ds_read_b128 v[204:207], v13 offset:27648
    ds_read_b128 v[208:211], v13 offset:28672
    ds_read_b128 v[160:163], v13 offset:29696
    ds_read_b128 v[164:167], v13 offset:30720
    ds_read_b128 v[168:171], v13 offset:31744
    ds_read_b128 v[172:175], v13 offset:32768
    s_cmp_eq_u32 s57, 0
    s_cbranch_scc0 L_km_kernel_cb_60
    s_barrier
L_km_kernel_cb_60:
    s_setprio 1
    s_waitcnt lgkmcnt(7)
    v_mfma_f32_16x16x32_bf16 v[176:179], v[192:195], v[112:115], v[176:179]
    v_mfma_f32_16x16x32_bf16 v[180:183], v[192:195], v[116:119], v[180:183]
    ds_read_b128 v[192:195], v13 offset:33792
    v_mfma_f32_16x16x32_bf16 v[184:187], v[196:199], v[112:115], v[184:187]
    v_mfma_f32_16x16x32_bf16 v[188:191], v[196:199], v[116:119], v[188:191]
    ds_read_b128 v[196:199], v13 offset:34816
    s_waitcnt lgkmcnt(7)
    v_mfma_f32_16x16x32_bf16 v[244:247], v[200:203], v[112:115], v[244:247]
    v_mfma_f32_16x16x32_bf16 v[248:251], v[200:203], v[116:119], v[248:251]
    ds_read_b128 v[200:203], v13 offset:35840
    v_mfma_f32_16x16x32_bf16 v[176:179], v[204:207], v[120:123], v[176:179]
    v_mfma_f32_16x16x32_bf16 v[180:183], v[204:207], v[124:127], v[180:183]
    s_waitcnt lgkmcnt(6)
    v_mfma_f32_16x16x32_bf16 v[184:187], v[208:211], v[120:123], v[184:187]
    v_mfma_f32_16x16x32_bf16 v[188:191], v[208:211], v[124:127], v[188:191]
    v_mfma_f32_16x16x32_bf16 v[244:247], v[160:163], v[120:123], v[244:247]
    v_mfma_f32_16x16x32_bf16 v[248:251], v[160:163], v[124:127], v[248:251]
    s_waitcnt lgkmcnt(4)
    s_waitcnt vmcnt(15)
    v_mfma_f32_16x16x32_bf16 v[176:179], v[164:167], v[128:131], v[176:179]
    v_mfma_f32_16x16x32_bf16 v[180:183], v[164:167], v[132:135], v[180:183]
    v_mfma_f32_16x16x32_bf16 v[184:187], v[168:171], v[128:131], v[184:187]
    v_mfma_f32_16x16x32_bf16 v[188:191], v[168:171], v[132:135], v[188:191]
    s_waitcnt lgkmcnt(2)
    v_mfma_f32_16x16x32_bf16 v[244:247], v[172:175], v[128:131], v[244:247]
    v_mfma_f32_16x16x32_bf16 v[248:251], v[172:175], v[132:135], v[248:251]
    s_waitcnt vmcnt(13)
    v_mfma_f32_16x16x32_bf16 v[176:179], v[192:195], v[136:139], v[176:179]
    v_mfma_f32_16x16x32_bf16 v[180:183], v[192:195], v[140:143], v[180:183]
    s_waitcnt lgkmcnt(0)
    v_mfma_f32_16x16x32_bf16 v[184:187], v[196:199], v[136:139], v[184:187]
    v_mfma_f32_16x16x32_bf16 v[188:191], v[196:199], v[140:143], v[188:191]
    v_mfma_f32_16x16x32_bf16 v[244:247], v[200:203], v[136:139], v[244:247]
    v_mfma_f32_16x16x32_bf16 v[248:251], v[200:203], v[140:143], v[248:251]
    s_setprio 0
    s_cmp_eq_u32 s57, 1
    s_cbranch_scc0 L_km_kernel_cb_61
    s_waitcnt vmcnt(10)
    s_barrier
L_km_kernel_cb_61:
    s_add_u32 m0, s68, 49152
    s_add_u32 s69, s66, 294912
    buffer_load_dwordx4 v1, s[32:35], s69 offen offset:0  lds
    buffer_load_dwordx4 v1, s[32:35], s69 offen offset:1024  lds
    buffer_load_dwordx4 v1, s[32:35], s69 offen offset:2048  lds
    ds_read_b128 v[192:195], v14 offset:0
    ds_read_b128 v[196:199], v14 offset:1024
    ds_read_b128 v[200:203], v14 offset:2048
    ds_read_b128 v[204:207], v14 offset:3072
    ds_read_b128 v[208:211], v14 offset:4096
    ds_read_b128 v[160:163], v14 offset:5120
    ds_read_b128 v[164:167], v14 offset:6144
    ds_read_b128 v[168:171], v14 offset:7168
    ds_read_b128 v[172:175], v14 offset:8192
    s_cmp_eq_u32 s57, 0
    s_cbranch_scc0 L_km_kernel_cb_62
    s_waitcnt vmcnt(13)
    s_barrier
L_km_kernel_cb_62:
    s_setprio 1
    s_waitcnt lgkmcnt(7)
    s_waitcnt vmcnt(11)
    v_mfma_f32_16x16x32_bf16 v[176:179], v[192:195], v[144:147], v[176:179]
    v_mfma_f32_16x16x32_bf16 v[180:183], v[192:195], v[148:151], v[180:183]
    ds_read_b128 v[192:195], v14 offset:9216
    v_mfma_f32_16x16x32_bf16 v[184:187], v[196:199], v[144:147], v[184:187]
    v_mfma_f32_16x16x32_bf16 v[188:191], v[196:199], v[148:151], v[188:191]
    ds_read_b128 v[196:199], v14 offset:10240
    s_waitcnt lgkmcnt(7)
    v_mfma_f32_16x16x32_bf16 v[244:247], v[200:203], v[144:147], v[244:247]
    v_mfma_f32_16x16x32_bf16 v[248:251], v[200:203], v[148:151], v[248:251]
    ds_read_b128 v[200:203], v14 offset:11264
    s_waitcnt vmcnt(9)
    v_mfma_f32_16x16x32_bf16 v[176:179], v[204:207], v[152:155], v[176:179]
    v_mfma_f32_16x16x32_bf16 v[180:183], v[204:207], v[156:159], v[180:183]
    s_waitcnt lgkmcnt(6)
    v_mfma_f32_16x16x32_bf16 v[184:187], v[208:211], v[152:155], v[184:187]
    v_mfma_f32_16x16x32_bf16 v[188:191], v[208:211], v[156:159], v[188:191]
    v_mfma_f32_16x16x32_bf16 v[244:247], v[160:163], v[152:155], v[244:247]
    v_mfma_f32_16x16x32_bf16 v[248:251], v[160:163], v[156:159], v[248:251]
    s_waitcnt lgkmcnt(4)
    v_mfma_f32_16x16x32_bf16 v[212:215], v[164:167], v[112:115], v[212:215]
    v_mfma_f32_16x16x32_bf16 v[216:219], v[164:167], v[116:119], v[216:219]
    v_mfma_f32_16x16x32_bf16 v[220:223], v[168:171], v[112:115], v[220:223]
    v_mfma_f32_16x16x32_bf16 v[224:227], v[168:171], v[116:119], v[224:227]
    s_waitcnt lgkmcnt(2)
    v_mfma_f32_16x16x32_bf16 v[212:215], v[172:175], v[120:123], v[212:215]
    v_mfma_f32_16x16x32_bf16 v[216:219], v[172:175], v[124:127], v[216:219]
    ds_write_b128 v8, v[180:183] offset:0
    ds_write_b128 v8, v[188:191] offset:8192
    v_mfma_f32_16x16x32_bf16 v[220:223], v[192:195], v[120:123], v[220:223]
    v_mfma_f32_16x16x32_bf16 v[224:227], v[192:195], v[124:127], v[224:227]
    s_waitcnt lgkmcnt(2)
    v_mfma_f32_16x16x32_bf16 v[212:215], v[196:199], v[128:131], v[212:215]
    v_mfma_f32_16x16x32_bf16 v[216:219], v[196:199], v[132:135], v[216:219]
    v_mfma_f32_16x16x32_bf16 v[220:223], v[200:203], v[128:131], v[220:223]
    v_mfma_f32_16x16x32_bf16 v[224:227], v[200:203], v[132:135], v[224:227]
    s_waitcnt lgkmcnt(0)
    s_setprio 0
    s_cmp_eq_u32 s57, 1
    s_cbranch_scc0 L_km_kernel_cb_63
    s_waitcnt vmcnt(6)
    s_barrier
L_km_kernel_cb_63:
    s_add_u32 m0, s68, 73728
    s_add_u32 s69, s66, 319488
    buffer_load_dwordx4 v1, s[32:35], s69 offen offset:0  lds
    buffer_load_dwordx4 v1, s[32:35], s69 offen offset:1024  lds
    buffer_load_dwordx4 v1, s[32:35], s69 offen offset:2048  lds
    ds_read_b128 v[192:195], v14 offset:24576
    ds_read_b128 v[196:199], v14 offset:25600
    ds_read_b128 v[200:203], v14 offset:26624
    ds_read_b128 v[204:207], v14 offset:27648
    ds_read_b128 v[208:211], v14 offset:28672
    ds_read_b128 v[160:163], v14 offset:29696
    ds_read_b128 v[164:167], v14 offset:30720
    ds_read_b128 v[168:171], v14 offset:31744
    ds_read_b128 v[172:175], v14 offset:32768
    s_cmp_eq_u32 s57, 0
    s_cbranch_scc0 L_km_kernel_cb_64
    s_waitcnt vmcnt(9)
    s_barrier
L_km_kernel_cb_64:
    s_setprio 1
    ds_read_b128 v[180:183], v9 offset:0
    ds_read_b128 v[188:191], v9 offset:8192
    s_waitcnt lgkmcnt(9)
    v_mfma_f32_16x16x32_bf16 v[212:215], v[192:195], v[136:139], v[212:215]
    v_mfma_f32_16x16x32_bf16 v[216:219], v[192:195], v[140:143], v[216:219]
    ds_read_b128 v[192:195], v14 offset:33792
    v_mfma_f32_16x16x32_bf16 v[220:223], v[196:199], v[136:139], v[220:223]
    s_waitcnt lgkmcnt(2)
    v_add_f32 v176, v176, v180
    v_add_f32 v177, v177, v181
    v_mfma_f32_16x16x32_bf16 v[224:227], v[196:199], v[140:143], v[224:227]
    v_add_f32 v178, v178, v182
    v_add_f32 v179, v179, v183
    v_mov_b32 v182, s10
    ds_read_b128 v[196:199], v14 offset:34816
    v_mfma_f32_16x16x32_bf16 v[212:215], v[200:203], v[144:147], v[212:215]
    v_cvt_pk_bf16_f32 v180, v176, v177
    v_cvt_pk_bf16_f32 v181, v178, v179
    s_add_u32 s71, s15, 0
    v_mfma_f32_16x16x32_bf16 v[216:219], v[200:203], v[148:151], v[216:219]
    buffer_store_dwordx3 v[180:182], v15, s[48:51], s71 offen sc1
    s_waitcnt lgkmcnt(2)
    ds_read_b128 v[200:203], v14 offset:35840
    v_mfma_f32_16x16x32_bf16 v[220:223], v[204:207], v[144:147], v[220:223]
    v_add_f32 v184, v184, v188
    v_add_f32 v185, v185, v189
    v_mfma_f32_16x16x32_bf16 v[224:227], v[204:207], v[148:151], v[224:227]
    v_add_f32 v186, v186, v190
    v_add_f32 v187, v187, v191
    v_mfma_f32_16x16x32_bf16 v[212:215], v[208:211], v[152:155], v[212:215]
    v_mov_b32 v190, s10
    v_cvt_pk_bf16_f32 v188, v184, v185
    v_mfma_f32_16x16x32_bf16 v[216:219], v[208:211], v[156:159], v[216:219]
    v_cvt_pk_bf16_f32 v189, v186, v187
    s_add_u32 s71, s15, 8192
    v_mfma_f32_16x16x32_bf16 v[220:223], v[160:163], v[152:155], v[220:223]
    buffer_store_dwordx3 v[188:190], v15, s[48:51], s71 offen sc1
    s_add_u32 s24, s4, 0x3ec1000
    v_mfma_f32_16x16x32_bf16 v[224:227], v[160:163], v[156:159], v[224:227]
    s_addc_u32 s25, s5, 0
    s_mov_b32 s26, 0x240000
    v_mfma_f32_16x16x32_bf16 v[228:231], v[164:167], v[112:115], v[228:231]
    s_mov_b32 s27, 0x20000
    s_mov_b32 s28, s4
    v_mfma_f32_16x16x32_bf16 v[232:235], v[164:167], v[116:119], v[232:235]
    s_mov_b32 s29, s5
    s_mov_b32 s30, 0x3600
    v_mfma_f32_16x16x32_bf16 v[236:239], v[168:171], v[112:115], v[236:239]
    s_mov_b32 s31, 0x20000
    s_mov_b32 s36, s6
    v_mfma_f32_16x16x32_bf16 v[240:243], v[168:171], v[116:119], v[240:243]
    s_mov_b32 s37, s7
    s_mov_b32 s38, 0x480
    s_waitcnt lgkmcnt(2)
    v_mfma_f32_16x16x32_bf16 v[228:231], v[172:175], v[120:123], v[228:231]
    s_mov_b32 s39, 0x20000
    s_mov_b32 s44, s8
    v_mfma_f32_16x16x32_bf16 v[232:235], v[172:175], v[124:127], v[232:235]
    s_mov_b32 s45, s9
    s_mov_b32 s46, 0x240000
    ds_write_b128 v10, v[216:219] offset:0
    ds_write_b128 v10, v[224:227] offset:8192
    ds_write_b128 v10, v[248:251] offset:16384
    v_mfma_f32_16x16x32_bf16 v[236:239], v[192:195], v[120:123], v[236:239]
    s_mov_b32 s47, 0x20000
    s_mul_i32 s59, s55, 9
    v_mfma_f32_16x16x32_bf16 v[240:243], v[192:195], v[124:127], v[240:243]
    s_lshl_b32 s60, s54, 1
    s_add_u32 s60, s60, s59
    s_waitcnt lgkmcnt(3)
    v_mfma_f32_16x16x32_bf16 v[228:231], v[196:199], v[128:131], v[228:231]
    s_add_u32 s59, s59, 8
    s_lshl_b32 s63, s60, 5
    v_mfma_f32_16x16x32_bf16 v[232:235], v[196:199], v[132:135], v[232:235]
    s_lshl_b32 s70, s59, 5
    s_lshl_b32 s62, s60, 6
    v_mfma_f32_16x16x32_bf16 v[236:239], v[200:203], v[128:131], v[236:239]
    v_mfma_f32_16x16x32_bf16 v[240:243], v[200:203], v[132:135], v[240:243]
    s_waitcnt lgkmcnt(0)
    s_setprio 0
    s_cmp_eq_u32 s57, 1
    s_cbranch_scc0 L_km_kernel_cb_65
    s_waitcnt vmcnt(8)
    s_barrier
L_km_kernel_cb_65:
    ds_read_b128 v[192:195], v12 offset:0
    ds_read_b128 v[196:199], v12 offset:1024
    ds_read_b128 v[200:203], v12 offset:2048
    ds_read_b128 v[204:207], v12 offset:3072
    ds_read_b128 v[208:211], v12 offset:4096
    ds_read_b128 v[176:179], v12 offset:5120
    ds_read_b128 v[180:183], v12 offset:6144
    ds_read_b128 v[184:187], v12 offset:7168
    ds_read_b128 v[188:191], v12 offset:8192
    s_cmp_eq_u32 s57, 0
    s_cbranch_scc0 L_km_kernel_cb_66
    s_waitcnt vmcnt(8)
    s_barrier
L_km_kernel_cb_66:
    s_setprio 1
    ds_read_b128 v[216:219], v11 offset:0
    ds_read_b128 v[224:227], v11 offset:8192
    ds_read_b128 v[248:251], v11 offset:16384
    s_waitcnt lgkmcnt(10)
    v_mfma_f32_16x16x32_bf16 v[228:231], v[192:195], v[136:139], v[228:231]
    v_mfma_f32_16x16x32_bf16 v[232:235], v[192:195], v[140:143], v[232:235]
    ds_read_b128 v[192:195], v12 offset:9216
    v_mfma_f32_16x16x32_bf16 v[236:239], v[196:199], v[136:139], v[236:239]
    s_waitcnt lgkmcnt(3)
    v_add_f32 v212, v212, v216
    v_add_f32 v213, v213, v217
    v_mfma_f32_16x16x32_bf16 v[240:243], v[196:199], v[140:143], v[240:243]
    v_add_f32 v214, v214, v218
    v_add_f32 v215, v215, v219
    v_mov_b32 v218, s10
    ds_read_b128 v[196:199], v12 offset:10240
    v_mfma_f32_16x16x32_bf16 v[228:231], v[200:203], v[144:147], v[228:231]
    v_cvt_pk_bf16_f32 v216, v212, v213
    v_cvt_pk_bf16_f32 v217, v214, v215
    s_add_u32 s71, s19, 0
    v_mfma_f32_16x16x32_bf16 v[232:235], v[200:203], v[148:151], v[232:235]
    buffer_store_dwordx3 v[216:218], v15, s[48:51], s71 offen sc1
    s_waitcnt lgkmcnt(3)
    v_add_f32 v220, v220, v224
    ds_read_b128 v[200:203], v12 offset:11264
    v_mfma_f32_16x16x32_bf16 v[236:239], v[204:207], v[144:147], v[236:239]
    v_add_f32 v221, v221, v225
    v_add_f32 v222, v222, v226
    v_add_f32 v223, v223, v227
    v_mfma_f32_16x16x32_bf16 v[240:243], v[204:207], v[148:151], v[240:243]
    v_mov_b32 v226, s10
    v_cvt_pk_bf16_f32 v224, v220, v221
    v_cvt_pk_bf16_f32 v225, v222, v223
    v_mfma_f32_16x16x32_bf16 v[228:231], v[208:211], v[152:155], v[228:231]
    s_add_u32 s71, s19, 8192
    buffer_store_dwordx3 v[224:226], v15, s[48:51], s71 offen sc1
    s_waitcnt lgkmcnt(3)
    v_mfma_f32_16x16x32_bf16 v[232:235], v[208:211], v[156:159], v[232:235]
    v_add_f32 v244, v244, v248
    v_add_f32 v245, v245, v249
    v_add_f32 v246, v246, v250
    v_mfma_f32_16x16x32_bf16 v[236:239], v[176:179], v[152:155], v[236:239]
    v_add_f32 v247, v247, v251
    v_mov_b32 v250, s10
    v_cvt_pk_bf16_f32 v248, v244, v245
    v_mfma_f32_16x16x32_bf16 v[240:243], v[176:179], v[156:159], v[240:243]
    v_cvt_pk_bf16_f32 v249, v246, v247
    s_add_u32 s71, s22, 0
    buffer_store_dwordx3 v[248:250], v15, s[48:51], s71 offen sc1
    v_mfma_f32_16x16x32_bf16 v[160:163], v[180:183], v[16:19], 0
    s_add_u32 s62, s62, 11520
    s_lshl_b32 s58, s59, 6
    s_add_u32 s58, s58, 11520
    v_mfma_f32_16x16x32_bf16 v[164:167], v[180:183], v[20:23], 0
    s_lshl_b32 s64, s53, 2
    s_add_u32 s64, s64, s56
    s_lshl_b32 s64, s64, 1
    v_mfma_f32_16x16x32_bf16 v[168:171], v[184:187], v[16:19], 0
    s_add_u32 s64, s64, s57
    s_lshl_b32 s61, s60, 16
    s_lshl_b32 s65, s59, 16
    v_mfma_f32_16x16x32_bf16 v[172:175], v[184:187], v[20:23], 0
    s_lshl_b32 s59, s64, 7
    s_add_u32 s61, s61, s59
    s_add_u32 s65, s65, s59
    s_waitcnt lgkmcnt(2)
    v_mfma_f32_16x16x32_bf16 v[160:163], v[188:191], v[24:27], v[160:163]
    s_add_u32 s67, s61, 0x10000
    s_lshl_b32 s75, s64, 9
    v_mfma_f32_16x16x32_bf16 v[164:167], v[188:191], v[28:31], v[164:167]
    s_mul_i32 s64, s64, 18432
    s_add_u32 s73, s64, s70
    ds_write_b128 v8, v[232:235] offset:0
    ds_write_b128 v8, v[240:243] offset:8192
    v_mfma_f32_16x16x32_bf16 v[168:171], v[192:195], v[24:27], v[168:171]
    s_add_u32 s64, s64, s63
    s_mul_i32 s74, s2, 72
    v_mfma_f32_16x16x32_bf16 v[172:175], v[192:195], v[28:31], v[172:175]
    s_add_u32 s74, s74, s57
    s_lshl_b32 s74, s74, 10
    s_waitcnt lgkmcnt(2)
    v_mfma_f32_16x16x32_bf16 v[160:163], v[196:199], v[32:35], v[160:163]
    s_lshl_b32 s72, s56, 11
    s_add_u32 s72, s72, s74
    v_mfma_f32_16x16x32_bf16 v[164:167], v[196:199], v[36:39], v[164:167]
    s_cmp_eq_u32 s56, s54
    s_cselect_b64 vcc, -1, 0
    v_mfma_f32_16x16x32_bf16 v[168:171], v[200:203], v[32:35], v[168:171]
    v_mfma_f32_16x16x32_bf16 v[172:175], v[200:203], v[36:39], v[172:175]
    s_waitcnt lgkmcnt(0)
    s_setprio 0
    s_cmp_eq_u32 s57, 1
    s_cbranch_scc0 L_km_kernel_cb_67
    s_waitcnt vmcnt(8)
    s_barrier
L_km_kernel_cb_67:
    ds_read_b128 v[192:195], v12 offset:24576
    ds_read_b128 v[196:199], v12 offset:25600
    ds_read_b128 v[200:203], v12 offset:26624
    ds_read_b128 v[204:207], v12 offset:27648
    ds_read_b128 v[208:211], v12 offset:28672
    ds_read_b128 v[176:179], v12 offset:29696
    ds_read_b128 v[180:183], v12 offset:30720
    ds_read_b128 v[184:187], v12 offset:31744
    ds_read_b128 v[188:191], v12 offset:32768
    s_cmp_eq_u32 s57, 0
    s_cbranch_scc0 L_km_kernel_cb_68
    s_waitcnt vmcnt(8)
    s_barrier
L_km_kernel_cb_68:
    s_setprio 1
    ds_read_b128 v[232:235], v9 offset:0
    ds_read_b128 v[240:243], v9 offset:8192
    s_waitcnt lgkmcnt(9)
    v_mfma_f32_16x16x32_bf16 v[160:163], v[192:195], v[40:43], v[160:163]
    v_mfma_f32_16x16x32_bf16 v[164:167], v[192:195], v[44:47], v[164:167]
    ds_read_b128 v[192:195], v12 offset:33792
    v_mfma_f32_16x16x32_bf16 v[168:171], v[196:199], v[40:43], v[168:171]
    s_waitcnt lgkmcnt(2)
    v_mfma_f32_16x16x32_bf16 v[172:175], v[196:199], v[44:47], v[172:175]
    v_add_f32 v228, v228, v232
    ds_read_b128 v[196:199], v12 offset:34816
    v_mfma_f32_16x16x32_bf16 v[160:163], v[200:203], v[48:51], v[160:163]
    v_add_f32 v229, v229, v233
    v_mfma_f32_16x16x32_bf16 v[164:167], v[200:203], v[52:55], v[164:167]
    v_add_f32 v230, v230, v234
    ds_read_b128 v[200:203], v12 offset:35840
    v_mfma_f32_16x16x32_bf16 v[168:171], v[204:207], v[48:51], v[168:171]
    v_add_f32 v231, v231, v235
    v_mfma_f32_16x16x32_bf16 v[172:175], v[204:207], v[52:55], v[172:175]
    v_mov_b32 v234, s10
    v_mfma_f32_16x16x32_bf16 v[160:163], v[208:211], v[56:59], v[160:163]
    v_cvt_pk_bf16_f32 v232, v228, v229
    v_mfma_f32_16x16x32_bf16 v[164:167], v[208:211], v[60:63], v[164:167]
    v_cvt_pk_bf16_f32 v233, v230, v231
    v_mfma_f32_16x16x32_bf16 v[168:171], v[176:179], v[56:59], v[168:171]
    s_add_u32 s71, s23, 0
    v_mfma_f32_16x16x32_bf16 v[172:175], v[176:179], v[60:63], v[172:175]
    buffer_store_dwordx3 v[232:234], v15, s[48:51], s71 offen sc1
    v_mfma_f32_16x16x32_bf16 v[160:163], v[180:183], v[64:67], v[160:163]
    s_waitcnt lgkmcnt(3)
    v_mfma_f32_16x16x32_bf16 v[164:167], v[180:183], v[68:71], v[164:167]
    v_add_f32 v236, v236, v240
    v_mfma_f32_16x16x32_bf16 v[168:171], v[184:187], v[64:67], v[168:171]
    v_add_f32 v237, v237, v241
    v_mfma_f32_16x16x32_bf16 v[172:175], v[184:187], v[68:71], v[172:175]
    v_add_f32 v238, v238, v242
    s_waitcnt lgkmcnt(2)
    v_mfma_f32_16x16x32_bf16 v[160:163], v[188:191], v[72:75], v[160:163]
    v_add_f32 v239, v239, v243
    v_mfma_f32_16x16x32_bf16 v[164:167], v[188:191], v[76:79], v[164:167]
    v_mov_b32 v242, s10
    v_mfma_f32_16x16x32_bf16 v[168:171], v[192:195], v[72:75], v[168:171]
    v_cvt_pk_bf16_f32 v240, v236, v237
    v_mfma_f32_16x16x32_bf16 v[172:175], v[192:195], v[76:79], v[172:175]
    v_cvt_pk_bf16_f32 v241, v238, v239
    s_waitcnt lgkmcnt(0)
    v_mfma_f32_16x16x32_bf16 v[160:163], v[196:199], v[80:83], v[160:163]
    s_add_u32 s71, s23, 8192
    v_mfma_f32_16x16x32_bf16 v[164:167], v[196:199], v[84:87], v[164:167]
    buffer_store_dwordx3 v[240:242], v15, s[48:51], s71 offen sc1
    v_mfma_f32_16x16x32_bf16 v[168:171], v[200:203], v[80:83], v[168:171]
    v_mfma_f32_16x16x32_bf16 v[172:175], v[200:203], v[84:87], v[172:175]
    s_setprio 0
    s_cmp_eq_u32 s57, 1
    s_cbranch_scc0 L_km_kernel_cb_69
    s_waitcnt vmcnt(7)
    s_barrier
L_km_kernel_cb_69:
    v_lshrrev_b32 v213, 8, v1
    v_and_b32 v212, 0xf0, v1
    v_lshrrev_b32 v215, 4, v212
    v_mul_u32_u24 v215, 1152, v215
    v_lshlrev_b32 v214, 3, v213
    v_add_u32 v215, v215, v214
    v_lshlrev_b32 v5, 1, v212
    v_lshrrev_b32 v212, 1, v212
    v_lshl_add_u32 v212, v213, 14, v212
    v_lshlrev_b32 v213, 4, v213
    buffer_load_dword v2, v5, s[40:43], s75 offen offset:20 sc1
    buffer_load_dwordx2 v[216:217], v212, s[24:27], s61 offen
    buffer_load_dwordx4 v[244:247], v213, s[28:31], s62 offen offset:0
    buffer_load_dwordx2 v[222:223], v214, s[36:39], s63 offen offset:0
    buffer_load_dwordx2 v[218:219], v212, s[24:27], s67 offen
    buffer_load_dwordx4 v[248:251], v213, s[28:31], s62 offen offset:64
    buffer_load_dwordx2 v[224:225], v214, s[36:39], s63 offen offset:32
    buffer_load_dwordx2 v[220:221], v212, s[24:27], s65 offen
    buffer_load_dwordx4 v[232:235], v213, s[28:31], s58 offen offset:0
    buffer_load_dwordx2 v[226:227], v214, s[36:39], s70 offen offset:0
    ds_read_b128 v[192:195], v13 offset:0
    ds_read_b128 v[196:199], v13 offset:1024
    ds_read_b128 v[200:203], v13 offset:2048
    ds_read_b128 v[204:207], v13 offset:3072
    ds_read_b128 v[208:211], v13 offset:4096
    ds_read_b128 v[176:179], v13 offset:5120
    ds_read_b128 v[180:183], v13 offset:6144
    ds_read_b128 v[184:187], v13 offset:7168
    ds_read_b128 v[188:191], v13 offset:8192
    s_cmp_eq_u32 s57, 0
    s_cbranch_scc0 L_km_kernel_cb_70
    s_waitcnt vmcnt(17)
    s_barrier
L_km_kernel_cb_70:
    s_setprio 1
    s_waitcnt lgkmcnt(7)
    v_mfma_f32_16x16x32_bf16 v[160:163], v[192:195], v[88:91], v[160:163]
    v_mfma_f32_16x16x32_bf16 v[164:167], v[192:195], v[92:95], v[164:167]
    ds_read_b128 v[192:195], v13 offset:9216
    v_mfma_f32_16x16x32_bf16 v[168:171], v[196:199], v[88:91], v[168:171]
    v_mfma_f32_16x16x32_bf16 v[172:175], v[196:199], v[92:95], v[172:175]
    ds_read_b128 v[196:199], v13 offset:10240
    s_waitcnt lgkmcnt(7)
    v_mfma_f32_16x16x32_bf16 v[160:163], v[200:203], v[96:99], v[160:163]
    v_mfma_f32_16x16x32_bf16 v[164:167], v[200:203], v[100:103], v[164:167]
    ds_read_b128 v[200:203], v13 offset:11264
    v_mfma_f32_16x16x32_bf16 v[168:171], v[204:207], v[96:99], v[168:171]
    v_mfma_f32_16x16x32_bf16 v[172:175], v[204:207], v[100:103], v[172:175]
    s_waitcnt lgkmcnt(6)
    v_mfma_f32_16x16x32_bf16 v[160:163], v[208:211], v[104:107], v[160:163]
    v_mfma_f32_16x16x32_bf16 v[164:167], v[208:211], v[108:111], v[164:167]
    v_mfma_f32_16x16x32_bf16 v[168:171], v[176:179], v[104:107], v[168:171]
    v_mfma_f32_16x16x32_bf16 v[172:175], v[176:179], v[108:111], v[172:175]
    s_waitcnt lgkmcnt(4)
    v_mfma_f32_16x16x32_bf16 v[160:163], v[180:183], v[112:115], v[160:163]
    v_mfma_f32_16x16x32_bf16 v[164:167], v[180:183], v[116:119], v[164:167]
    v_mfma_f32_16x16x32_bf16 v[168:171], v[184:187], v[112:115], v[168:171]
    v_mfma_f32_16x16x32_bf16 v[172:175], v[184:187], v[116:119], v[172:175]
    s_waitcnt lgkmcnt(2)
    v_mfma_f32_16x16x32_bf16 v[160:163], v[188:191], v[120:123], v[160:163]
    v_mfma_f32_16x16x32_bf16 v[164:167], v[188:191], v[124:127], v[164:167]
    v_mfma_f32_16x16x32_bf16 v[168:171], v[192:195], v[120:123], v[168:171]
    v_mfma_f32_16x16x32_bf16 v[172:175], v[192:195], v[124:127], v[172:175]
    s_waitcnt lgkmcnt(0)
    v_mfma_f32_16x16x32_bf16 v[160:163], v[196:199], v[128:131], v[160:163]
    v_mfma_f32_16x16x32_bf16 v[164:167], v[196:199], v[132:135], v[164:167]
    v_mfma_f32_16x16x32_bf16 v[168:171], v[200:203], v[128:131], v[168:171]
    v_mfma_f32_16x16x32_bf16 v[172:175], v[200:203], v[132:135], v[172:175]
    s_setprio 0
    s_cmp_eq_u32 s57, 1
    s_cbranch_scc0 L_km_kernel_cb_71
    s_barrier
L_km_kernel_cb_71:
    ds_read_b128 v[192:195], v13 offset:24576
    ds_read_b128 v[196:199], v13 offset:25600
    ds_read_b128 v[200:203], v13 offset:26624
    ds_read_b128 v[204:207], v13 offset:27648
    ds_read_b128 v[208:211], v13 offset:28672
    ds_read_b128 v[176:179], v13 offset:29696
    s_cmp_eq_u32 s57, 0
    s_cbranch_scc0 L_km_kernel_cb_72
    s_barrier
L_km_kernel_cb_72:
    s_setprio 1
    s_waitcnt lgkmcnt(4)
    v_mfma_f32_16x16x32_bf16 v[160:163], v[192:195], v[136:139], v[160:163]
    v_mfma_f32_16x16x32_bf16 v[164:167], v[192:195], v[140:143], v[164:167]
    v_mfma_f32_16x16x32_bf16 v[168:171], v[196:199], v[136:139], v[168:171]
    v_mfma_f32_16x16x32_bf16 v[172:175], v[196:199], v[140:143], v[172:175]
    s_waitcnt lgkmcnt(2)
    v_mfma_f32_16x16x32_bf16 v[160:163], v[200:203], v[144:147], v[160:163]
    v_mfma_f32_16x16x32_bf16 v[164:167], v[200:203], v[148:151], v[164:167]
    v_mfma_f32_16x16x32_bf16 v[168:171], v[204:207], v[144:147], v[168:171]
    v_mfma_f32_16x16x32_bf16 v[172:175], v[204:207], v[148:151], v[172:175]
    s_waitcnt lgkmcnt(0)
    v_mfma_f32_16x16x32_bf16 v[160:163], v[208:211], v[152:155], v[160:163]
    v_mfma_f32_16x16x32_bf16 v[164:167], v[208:211], v[156:159], v[164:167]
    v_mfma_f32_16x16x32_bf16 v[168:171], v[176:179], v[152:155], v[168:171]
    v_mfma_f32_16x16x32_bf16 v[172:175], v[176:179], v[156:159], v[172:175]
    s_nop 5
    ds_write_b128 v10, v[164:167] offset:24576
    s_nop 0
    ds_write_b128 v10, v[172:175] offset:32768
    s_waitcnt lgkmcnt(0)
    s_setprio 0
    s_cmp_eq_u32 s57, 1
    s_cbranch_scc0 L_km_kernel_cb_73
    s_barrier
L_km_kernel_cb_73:
    s_cmp_eq_u32 s57, 0
    s_cbranch_scc0 L_km_kernel_cb_74
    s_barrier
L_km_kernel_cb_74:
    ds_read_b128 v[164:167], v11 offset:24576
    ds_read_b128 v[172:175], v11 offset:32768
    s_waitcnt lgkmcnt(1)
    v_add_f32 v160, v160, v164
    v_add_f32 v161, v161, v165
    v_add_f32 v162, v162, v166
    v_add_f32 v163, v163, v167
    s_waitcnt lgkmcnt(0)
    v_add_f32 v168, v168, v172
    v_add_f32 v169, v169, v173
    v_add_f32 v170, v170, v174
    v_add_f32 v171, v171, v175
L_km_kernel_psp_76:
    s_waitcnt vmcnt(0)
    v_cmp_ne_u32 s[76:77], s10, v18
    v_cmp_ne_u32 s[78:79], s10, v22
    s_nop 0
    s_or_b64 s[76:77], s[76:77], s[78:79]
    v_cmp_ne_u32 s[78:79], s10, v26
    s_nop 0
    s_or_b64 s[76:77], s[76:77], s[78:79]
    v_cmp_ne_u32 s[78:79], s10, v30
    s_nop 0
    s_or_b64 s[76:77], s[76:77], s[78:79]
    v_cmp_ne_u32 s[78:79], s10, v34
    s_nop 0
    s_or_b64 s[76:77], s[76:77], s[78:79]
    v_cmp_ne_u32 s[78:79], s10, v38
    s_nop 0
    s_or_b64 s[76:77], s[76:77], s[78:79]
    s_cbranch_vccz L_km_kernel_pn8_77
    v_cmp_ne_u32 s[78:79], s10, v42
    s_nop 0
    s_or_b64 s[76:77], s[76:77], s[78:79]
    v_cmp_ne_u32 s[78:79], s10, v46
    s_nop 0
    s_or_b64 s[76:77], s[76:77], s[78:79]
    v_cmp_ne_u32 s[78:79], s10, v50
    s_nop 0
    s_or_b64 s[76:77], s[76:77], s[78:79]
    v_cmp_ne_u32 s[78:79], s10, v54
    s_nop 0
    s_or_b64 s[76:77], s[76:77], s[78:79]
L_km_kernel_pn8_77:
    s_cmp_eq_u64 s[76:77], 0
    s_cbranch_scc1 L_km_kernel_pok_75
    s_sleep 0
    s_add_u32 s60, s72, 0
    buffer_load_dwordx3 v[16:18], v15, s[48:51], s60 offen sc1
    s_add_u32 s60, s72, 8192
    buffer_load_dwordx3 v[20:22], v15, s[48:51], s60 offen sc1
    s_add_u32 s60, s72, 18432
    buffer_load_dwordx3 v[24:26], v15, s[48:51], s60 offen sc1
    s_add_u32 s60, s72, 26624
    buffer_load_dwordx3 v[28:30], v15, s[48:51], s60 offen sc1
    s_add_u32 s60, s72, 36864
    buffer_load_dwordx3 v[32:34], v15, s[48:51], s60 offen sc1
    s_add_u32 s60, s72, 45056
    buffer_load_dwordx3 v[36:38], v15, s[48:51], s60 offen sc1
    s_cbranch_vccz L_km_kernel_p8_78
    s_add_u32 s60, s74, 16384
    buffer_load_dwordx3 v[40:42], v15, s[48:51], s60 offen sc1
    s_add_u32 s60, s74, 34816
    buffer_load_dwordx3 v[44:46], v15, s[48:51], s60 offen sc1
    s_add_u32 s60, s74, 53248
    buffer_load_dwordx3 v[48:50], v15, s[48:51], s60 offen sc1
    s_add_u32 s60, s74, 71680
    buffer_load_dwordx3 v[52:54], v15, s[48:51], s60 offen sc1
L_km_kernel_p8_78:
    s_sub_u32 s3, s3, 1
    s_cbranch_scc0 L_km_kernel_psp_76
    s_waitcnt vmcnt(0)
L_km_kernel_pok_75:
    v_rcp_f32 v2, v2
    v_lshlrev_b32 v64, 16, v16
    v_and_b32 v65, 0xffff0000, v16
    v_lshlrev_b32 v66, 16, v17
    v_and_b32 v67, 0xffff0000, v17
    v_add_f32 v160, v160, v64
    v_add_f32 v161, v161, v65
    v_add_f32 v162, v162, v66
    v_add_f32 v163, v163, v67
    v_lshlrev_b32 v64, 16, v24
    v_and_b32 v65, 0xffff0000, v24
    v_lshlrev_b32 v66, 16, v25
    v_and_b32 v67, 0xffff0000, v25
    v_add_f32 v160, v160, v64
    v_add_f32 v161, v161, v65
    v_add_f32 v162, v162, v66
    v_add_f32 v163, v163, v67
    v_lshlrev_b32 v64, 16, v32
    v_and_b32 v65, 0xffff0000, v32
    v_lshlrev_b32 v66, 16, v33
    v_and_b32 v67, 0xffff0000, v33
    v_add_f32 v160, v160, v64
    v_add_f32 v161, v161, v65
    v_add_f32 v162, v162, v66
    v_add_f32 v163, v163, v67
    v_lshlrev_b32 v64, 16, v222
    v_and_b32 v65, 0xffff0000, v222
    v_lshlrev_b32 v68, 16, v216
    v_and_b32 v69, 0xffff0000, v216
    v_lshlrev_b32 v66, 16, v223
    v_and_b32 v67, 0xffff0000, v223
    v_lshlrev_b32 v70, 16, v217
    v_and_b32 v71, 0xffff0000, v217
    v_fma_f32 v160, v160, v2, v64
    v_fma_f32 v161, v161, v2, v65
    v_fma_f32 v162, v162, v2, v66
    v_fma_f32 v163, v163, v2, v67
    v_fma_f32 v160, v160, v244, v68
    v_fma_f32 v161, v161, v245, v69
    v_fma_f32 v162, v162, v246, v70
    v_fma_f32 v163, v163, v247, v71
    v_cvt_pk_bf16_f32 v72, v160, v161
    v_cvt_pk_bf16_f32 v73, v162, v163
    buffer_store_dwordx2 v[72:73], v215, s[44:47], s64 offen offset:0
    v_lshlrev_b32 v76, 16, v20
    v_and_b32 v77, 0xffff0000, v20
    v_lshlrev_b32 v78, 16, v21
    v_and_b32 v79, 0xffff0000, v21
    v_add_f32 v168, v168, v76
    v_add_f32 v169, v169, v77
    v_add_f32 v170, v170, v78
    v_add_f32 v171, v171, v79
    v_lshlrev_b32 v76, 16, v28
    v_and_b32 v77, 0xffff0000, v28
    v_lshlrev_b32 v78, 16, v29
    v_and_b32 v79, 0xffff0000, v29
    v_add_f32 v168, v168, v76
    v_add_f32 v169, v169, v77
    v_add_f32 v170, v170, v78
    v_add_f32 v171, v171, v79
    v_lshlrev_b32 v76, 16, v36
    v_and_b32 v77, 0xffff0000, v36
    v_lshlrev_b32 v78, 16, v37
    v_and_b32 v79, 0xffff0000, v37
    v_add_f32 v168, v168, v76
    v_add_f32 v169, v169, v77
    v_add_f32 v170, v170, v78
    v_add_f32 v171, v171, v79
    v_lshlrev_b32 v76, 16, v224
    v_and_b32 v77, 0xffff0000, v224
    v_lshlrev_b32 v80, 16, v218
    v_and_b32 v81, 0xffff0000, v218
    v_lshlrev_b32 v78, 16, v225
    v_and_b32 v79, 0xffff0000, v225
    v_lshlrev_b32 v82, 16, v219
    v_and_b32 v83, 0xffff0000, v219
    v_fma_f32 v168, v168, v2, v76
    v_fma_f32 v169, v169, v2, v77
    v_fma_f32 v170, v170, v2, v78
    v_fma_f32 v171, v171, v2, v79
    v_fma_f32 v168, v168, v248, v80
    v_fma_f32 v169, v169, v249, v81
    v_fma_f32 v170, v170, v250, v82
    v_fma_f32 v171, v171, v251, v83
    v_cvt_pk_bf16_f32 v84, v168, v169
    v_cvt_pk_bf16_f32 v85, v170, v171
    buffer_store_dwordx2 v[84:85], v215, s[44:47], s64 offen offset:32
    s_cbranch_vccz L_km_fin
    v_lshlrev_b32 v104, 16, v40
    v_and_b32 v105, 0xffff0000, v40
    v_lshlrev_b32 v106, 16, v41
    v_and_b32 v107, 0xffff0000, v41
    v_lshlrev_b32 v88, 16, v44
    v_and_b32 v89, 0xffff0000, v44
    v_lshlrev_b32 v90, 16, v45
    v_and_b32 v91, 0xffff0000, v45
    v_add_f32 v104, v104, v88
    v_add_f32 v105, v105, v89
    v_add_f32 v106, v106, v90
    v_add_f32 v107, v107, v91
    v_lshlrev_b32 v88, 16, v48
    v_and_b32 v89, 0xffff0000, v48
    v_lshlrev_b32 v90, 16, v49
    v_and_b32 v91, 0xffff0000, v49
    v_add_f32 v104, v104, v88
    v_add_f32 v105, v105, v89
    v_add_f32 v106, v106, v90
    v_add_f32 v107, v107, v91
    v_lshlrev_b32 v88, 16, v52
    v_and_b32 v89, 0xffff0000, v52
    v_lshlrev_b32 v90, 16, v53
    v_and_b32 v91, 0xffff0000, v53
    v_add_f32 v104, v104, v88
    v_add_f32 v105, v105, v89
    v_add_f32 v106, v106, v90
    v_add_f32 v107, v107, v91
    v_lshlrev_b32 v88, 16, v226
    v_and_b32 v89, 0xffff0000, v226
    v_lshlrev_b32 v92, 16, v220
    v_and_b32 v93, 0xffff0000, v220
    v_lshlrev_b32 v90, 16, v227
    v_and_b32 v91, 0xffff0000, v227
    v_lshlrev_b32 v94, 16, v221
    v_and_b32 v95, 0xffff0000, v221
    v_fma_f32 v104, v104, v2, v88
    v_fma_f32 v105, v105, v2, v89
    v_fma_f32 v106, v106, v2, v90
    v_fma_f32 v107, v107, v2, v91
    v_fma_f32 v104, v104, v232, v92
    v_fma_f32 v105, v105, v233, v93
    v_fma_f32 v106, v106, v234, v94
    v_fma_f32 v107, v107, v235, v95
    v_cvt_pk_bf16_f32 v96, v104, v105
    v_cvt_pk_bf16_f32 v97, v106, v107
    buffer_store_dwordx2 v[96:97], v215, s[44:47], s73 offen offset:0
L_km_fin:
L_km_end:
    s_endpgm
.section .rodata,"a"
.p2align 6
.amdhsa_kernel ab_kernel
  .amdhsa_next_free_vgpr 253
  .amdhsa_next_free_sgpr 82
  .amdhsa_accum_offset 256
  .amdhsa_group_segment_fixed_size 0
  .amdhsa_kernarg_size 152
  .amdhsa_user_sgpr_count 2
  .amdhsa_user_sgpr_kernarg_segment_ptr 1
  .amdhsa_system_sgpr_workgroup_id_x 1
.end_amdhsa_kernel
.section .rodata,"a"
.p2align 6
.amdhsa_kernel km_kernel
  .amdhsa_next_free_vgpr 256
  .amdhsa_next_free_sgpr 80
  .amdhsa_accum_offset 256
  .amdhsa_group_segment_fixed_size 0
  .amdhsa_kernarg_size 152
  .amdhsa_user_sgpr_count 2
  .amdhsa_user_sgpr_kernarg_segment_ptr 1
  .amdhsa_system_sgpr_workgroup_id_x 1
.end_amdhsa_kernel
```
